```python
import torch

def _softmax(x, axis=-1):
    return torch.softmax(x, dim=axis)
def _gelu(x):
    return torch.nn.functional.gelu(x, approximate="tanh")
def _silu(x):
    return torch.nn.functional.silu(x)
def _sigmoid(x):
    return torch.sigmoid(x)
def _layernorm(x, axis=-1, eps=1e-5):
    m = x.mean(dim=axis, keepdim=True)
    v = x.var(dim=axis, keepdim=True, unbiased=False)
    return (x - m) / torch.sqrt(v + eps)
def _scatter_add(tgt, idx, src, axis=0):
    return tgt.clone().index_add_(axis, idx, src)
def _segment_sum(src, seg, n):
    out = torch.zeros((n,) + src.shape[1:], dtype=src.dtype)
    return out.index_add_(0, seg, src)
def _pad(x, pw):
    flat = tuple(v for pair in reversed(pw) for v in pair)
    return torch.nn.functional.pad(x, flat)

kernel_name = 'parallel_sum__ssm_conv_s5__glu_gated_swiglu__prompt'

def setup_inputs():

    _w = (lambda a: (lambda t: t.to(torch.bfloat16) if t.is_floating_point() else t)(torch.as_tensor(a)))
    def _A_setup():
        B, S, D = 1, 2048, 512
        P = D
        Lambda_re = -0.5 * (lambda _x: torch.exp(torch.as_tensor(_x)))((lambda *s: torch.randn(*s, dtype=torch.bfloat16) * 0.2)(P))
        Lambda_im = (lambda *s: torch.randn(*s, dtype=torch.bfloat16) * 0.8)(P) * 1.0
        B_re = (lambda *s: torch.randn(*s, dtype=torch.bfloat16) * 0.2)(P, D) * (D ** -0.5)
        B_im = (lambda *s: torch.randn(*s, dtype=torch.bfloat16) * 0.2)(P, D) * (D ** -0.5)
        C_re = (lambda *s: torch.randn(*s, dtype=torch.bfloat16) * 0.2)(D, P) * (P ** -0.5)
        C_im = (lambda *s: torch.randn(*s, dtype=torch.bfloat16) * 0.2)(D, P) * (P ** -0.5)
        log_dt = (lambda *s: torch.randn(*s, dtype=torch.bfloat16) * 0.2)(P) * 0.3 - 2.0
        Dskip = (lambda *s: torch.randn(*s, dtype=torch.bfloat16) * 0.05)(D)
        return {
            "x": _w((lambda *s: torch.randn(*s, dtype=torch.bfloat16) * 0.05)(B, S, D)),
            "Lambda_re": _w(Lambda_re),
            "Lambda_im": _w(Lambda_im),
            "B_re": _w(B_re),
            "B_im": _w(B_im),
            "C_re": _w(C_re),
            "C_im": _w(C_im),
            "log_dt": _w(log_dt),
            "Dskip": _w(Dskip),
        }
    _A_in = _A_setup()

    def _B_setup():
        B, S, D, F = 1, 2048, 512, 1792
        return {
            "x": _w((lambda *s: torch.randn(*s, dtype=torch.bfloat16) * 0.05)(B, S, D)),
            "w1": _w((lambda *s: torch.randn(*s, dtype=torch.bfloat16) * 0.4)(D, F) * (2.0 / D) ** 0.5),
            "w3": _w((lambda *s: torch.randn(*s, dtype=torch.bfloat16) * 0.4)(D, F) * (2.0 / D) ** 0.5),
            "w2": _w((lambda *s: torch.randn(*s, dtype=torch.bfloat16) * 0.4)(F, D) * (2.0 / F) ** 0.5),
        }
    _B_in = _B_setup()

    return {
        "A_x": _A_in["x"],
        "A_Lambda_re": _A_in["Lambda_re"],
        "A_Lambda_im": _A_in["Lambda_im"],
        "A_B_re": _A_in["B_re"],
        "A_B_im": _A_in["B_im"],
        "A_C_re": _A_in["C_re"],
        "A_C_im": _A_in["C_im"],
        "A_log_dt": _A_in["log_dt"],
        "A_Dskip": _A_in["Dskip"],
        "B_x": _B_in["x"],
        "B_w1": _B_in["w1"],
        "B_w3": _B_in["w3"],
        "B_w2": _B_in["w2"],
    }

def reference(A_x, A_Lambda_re, A_Lambda_im, A_B_re, A_B_im, A_C_re, A_C_im, A_log_dt, A_Dskip, B_x, B_w1, B_w3, B_w2):
    def _A_ref(x, Lambda_re, Lambda_im, B_re, B_im, C_re, C_im, log_dt, Dskip):
        Bsz, L, H = x.shape
        Lam = Lambda_re + 1j * Lambda_im
        Bmat = B_re + 1j * B_im
        Cmat = C_re + 1j * C_im
        dt = torch.exp(log_dt)
        Lam_bar = torch.exp(dt * Lam)
        B_bar = ((Lam_bar - 1.0) / Lam)[:, None] * Bmat
        Bu = torch.einsum("bld,pd->blp", x + 0j, B_bar)
        h = torch.zeros_like(Bu[:, 0, :])
        hs = []
        for t in range(L):
            h = Lam_bar[None, :] * h + Bu[:, t, :]
            hs.append(h)
        hseq = torch.stack(hs, 1)
        y = 2.0 * torch.einsum("blp,dp->bld", hseq, Cmat).real + x * Dskip[None, None, :]
        return y

    def _B_ref(x, w1, w3, w2):
        gate = torch.einsum("bsd,df->bsf", x, w1)
        up = torch.einsum("bsd,df->bsf", x, w3)
        h = _silu(gate) * up
        out = torch.einsum("bsf,fd->bsd", h, w2)
        return out

    x = A_x
    xn = _layernorm(x, axis=-1)
    return x + _A_ref(xn, A_Lambda_re, A_Lambda_im, A_B_re, A_B_im, A_C_re, A_C_im, A_log_dt, A_Dskip) + _B_ref(xn, B_w1, B_w3, B_w2)
```

```asm
; @launch grid=(256,1,1) block=(512,1,1) lds=163840
.amdgcn_target "amdgcn-amd-amdhsa--gfx950"
.text
.globl parallel_sum__ssm_conv_s5__glu_gated_swiglu__prompt_kernel
.p2align 8
.type parallel_sum__ssm_conv_s5__glu_gated_swiglu__prompt_kernel,@function
parallel_sum__ssm_conv_s5__glu_gated_swiglu__prompt_kernel:
    s_cmp_ge_u32 s2, 256
    s_cbranch_scc1 K1_END
    s_mov_b32 s32, 0
    s_load_dwordx16 s[36:51], s[0:1], 0
    s_load_dwordx16 s[52:67], s[0:1], 64
    v_lshrrev_b32 v1, 6, v0
    v_and_b32 v0, 63, v0
    s_nop 0
    v_readfirstlane_b32 s3, v1
    s_and_b32 s72, s2, 7
    s_lshr_b32 s73, s2, 3
    s_lshr_b32 s6, s72, 1
    s_lshl_b32 s6, s6, 2
    s_lshr_b32 s74, s73, 3
    s_add_u32 s6, s6, s74
    s_and_b32 s7, s72, 1
    s_lshl_b32 s7, s7, 3
    s_and_b32 s74, s73, 7
    s_add_u32 s7, s7, s74
    s_and_b32 s4, s3, 3
    s_lshr_b32 s5, s3, 2
    s_lshl_b32 s75, s3, 10
    s_lshl_b32 s76, s3, 11
    s_lshl_b32 s77, s5, 13
    s_lshl_b32 s74, s4, 11
    s_add_u32 s77, s77, s74
    s_lshl_b32 s78, s6, 17
    s_lshr_b32 s74, s7, 2
    s_mul_i32 s74, s74, 896
    s_and_b32 s83, s7, 3
    s_mov_b32 s80, 128
    s_cmp_eq_u32 s83, 1
    s_cselect_b32 s80, 384, s80
    s_cmp_eq_u32 s83, 2
    s_cselect_b32 s80, 448, s80
    s_cmp_eq_u32 s83, 3
    s_cselect_b32 s80, 704, s80
    s_add_u32 s80, s80, s74
    s_mov_b32 s81, 0
    s_cmp_eq_u32 s83, 1
    s_cselect_b32 s81, 256, s81
    s_cmp_eq_u32 s83, 2
    s_cselect_b32 s81, 512, s81
    s_cmp_eq_u32 s83, 3
    s_cselect_b32 s81, 768, s81
    s_add_u32 s81, s81, s74
    s_mov_b32 s82, 192
    s_cmp_eq_u32 s83, 1
    s_cselect_b32 s82, 192, s82
    s_cmp_eq_u32 s83, 2
    s_cselect_b32 s82, 640, s82
    s_cmp_eq_u32 s83, 3
    s_cselect_b32 s82, 640, s82
    s_add_u32 s82, s82, s74
    s_mov_b32 s79, 192
    s_cmp_eq_u32 s83, 1
    s_cselect_b32 s79, 224, s79
    s_cmp_eq_u32 s83, 2
    s_cselect_b32 s79, 640, s79
    s_cmp_eq_u32 s83, 3
    s_cselect_b32 s79, 672, s79
    s_add_u32 s79, s79, s74
    v_lshrrev_b32 v2, 3, v0
    v_and_b32 v3, 7, v0
    v_lshrrev_b32 v4, 1, v2
    v_xor_b32 v5, v3, v4
    s_lshl_b32 s74, s3, 14
    v_lshlrev_b32 v6, 10, v2
    v_lshl_add_u32 v6, v5, 4, v6
    v_add_u32 v20, s74, v6
    v_xor_b32 v7, 4, v5
    v_lshlrev_b32 v8, 10, v2
    v_lshl_add_u32 v8, v7, 4, v8
    s_add_u32 s83, s74, 8192
    v_add_u32 v21, s83, v8
    s_and_b32 s74, s4, 1
    s_lshl_b32 s74, s74, 2
    v_xor_b32 v7, s74, v5
    v_lshlrev_b32 v8, 10, v2
    v_lshl_add_u32 v8, v7, 4, v8
    s_lshl_b32 s74, s7, 15
    s_lshl_b32 s83, s4, 13
    s_add_u32 s74, s74, s83
    v_add_u32 v22, s74, v8
    v_lshrrev_b32 v6, 2, v0
    s_lshl_b32 s74, s4, 4
    v_add_u32 v6, s74, v6
    s_movk_i32 s83, 3584
    v_mul_lo_u32 v6, v6, s83
    v_and_b32 v7, 3, v0
    s_lshl_b32 s74, s5, 1
    v_xor_b32 v7, s74, v7
    v_lshl_add_u32 v23, v7, 4, v6
    v_bfe_u32 v6, v2, 1, 1
    s_lshl_b32 s74, s5, 1
    v_or_b32 v6, s74, v6
    v_lshlrev_b32 v6, 1, v6
    v_xor_b32 v6, v3, v6
    s_lshl_b32 s74, s4, 4
    v_add_u32 v7, s74, v2
    v_mul_lo_u32 v7, v7, s83
    v_lshl_add_u32 v24, v6, 4, v7
    v_lshlrev_b32 v27, 4, v0
    s_waitcnt lgkmcnt(0)
    s_mov_b32 s8, s36
    s_mov_b32 s9, s37
    s_mov_b32 s10, 2097152
    s_mov_b32 s11, 0x00020000
    s_cmp_eq_u32 s5, 0
    s_cselect_b32 s12, s42, s44
    s_cselect_b32 s13, s43, s45
    s_mov_b32 s14, 524288
    s_mov_b32 s15, 0x00020000
    s_cselect_b32 s16, s56, s58
    s_cselect_b32 s17, s57, s59
    s_mov_b32 s18, 1835008
    s_mov_b32 s19, 0x00020000
    s_mov_b32 s20, s66
    s_mov_b32 s21, s67
    s_mov_b32 s22, 11534336
    s_mov_b32 s23, 0x00020000
    s_add_u32 s24, s66, 14417920
    s_addc_u32 s25, s67, 0
    s_mov_b32 s26, 544768
    s_mov_b32 s27, 0x00020000
    s_cmp_lg_u32 s2, 0
    s_cbranch_scc1 K1_NONONCE
    s_cmp_lg_u32 s3, 0
    s_cbranch_scc1 K1_NONONCE
    s_memrealtime s[86:87]
    s_waitcnt lgkmcnt(0)
    s_or_b32 s86, s86, 1
    v_mov_b32 v6, s86
    v_mov_b32 v7, 0
    s_mov_b64 exec, 1
    global_store_dword v7, v6, s[64:65] sc0 sc1
    s_mov_b64 exec, -1
K1_NONONCE:
    s_cmp_lg_u32 s3, 7
    s_cbranch_scc1 K1_NOPOLL
    v_mov_b32 v7, 0
    global_load_dword v12, v7, s[64:65] sc1
K1_NOPOLL:
    s_lshr_b32 s88, s6, 2
    s_and_b32 s89, s6, 3
    s_lshl_b32 s90, s7, 3
    s_add_u32 s90, s90, s3
    s_lshl_b32 s90, s90, 10
    s_add_u32 s90, s90, s78
    buffer_load_dwordx4 v[48:51], v27, s[8:11], s90 offen
    s_mov_b32 s28, s38
    s_mov_b32 s29, s39
    s_mov_b32 s30, 1024
    s_mov_b32 s31, 0x00020000
    v_and_b32 v6, 31, v0
    s_lshl_b32 s90, s7, 6
    v_lshl_add_u32 v6, v6, 1, s90
    buffer_load_ushort v1, v6, s[28:31], 0 offen
    s_mov_b32 s28, s40
    s_mov_b32 s29, s41
    buffer_load_ushort v18, v6, s[28:31], 0 offen
    s_mov_b32 s28, s50
    s_mov_b32 s29, s51
    buffer_load_ushort v19, v6, s[28:31], 0 offen
    s_mov_b32 s90, 0
    s_add_u32 s91, s90, 0
    s_and_b32 s91, s91, 7
    s_lshl_b32 s36, s91, 7
    s_mul_i32 s50, s91, 229376
    s_add_u32 s91, s90, 1
    s_and_b32 s91, s91, 7
    s_lshl_b32 s37, s91, 7
    s_mul_i32 s51, s91, 229376
    s_add_u32 s91, s90, 2
    s_and_b32 s91, s91, 7
    s_lshl_b32 s38, s91, 7
    s_mul_i32 s52, s91, 229376
    s_add_u32 s91, s90, 3
    s_and_b32 s91, s91, 7
    s_lshl_b32 s39, s91, 7
    s_mul_i32 s53, s91, 229376
    s_add_u32 s91, s90, 4
    s_and_b32 s91, s91, 7
    s_lshl_b32 s40, s91, 7
    s_mul_i32 s54, s91, 229376
    s_add_u32 s91, s90, 5
    s_and_b32 s91, s91, 7
    s_lshl_b32 s41, s91, 7
    s_mul_i32 s55, s91, 229376
    s_add_u32 s91, s90, 6
    s_and_b32 s91, s91, 7
    s_lshl_b32 s42, s91, 7
    s_mul_i32 s56, s91, 229376
    s_add_u32 s91, s90, 7
    s_and_b32 s91, s91, 7
    s_lshl_b32 s43, s91, 7
    s_mul_i32 s57, s91, 229376
    s_add_u32 m0, s76, 0
    s_add_u32 s84, s78, s36
    buffer_load_dwordx4 v20, s[8:11], s84 offen lds
    s_add_u32 m0, s76, 1024
    s_add_u32 s84, s78, s36
    buffer_load_dwordx4 v21, s[8:11], s84 offen lds
    s_add_u32 m0, s75, 16384
    s_mov_b32 s84, s36
    buffer_load_dwordx4 v22, s[12:15], s84 offen lds
    s_add_u32 m0, s75, 24576
    s_add_u32 s84, s80, s50
    buffer_load_dwordx4 v23, s[16:19], s84 offen lds
    s_add_u32 m0, s76, 32768
    s_add_u32 s84, s78, s37
    buffer_load_dwordx4 v20, s[8:11], s84 offen lds
    s_add_u32 m0, s76, 33792
    s_add_u32 s84, s78, s37
    buffer_load_dwordx4 v21, s[8:11], s84 offen lds
    s_add_u32 m0, s75, 49152
    s_mov_b32 s84, s37
    buffer_load_dwordx4 v22, s[12:15], s84 offen lds
    s_add_u32 m0, s75, 57344
    s_add_u32 s84, s80, s51
    buffer_load_dwordx4 v23, s[16:19], s84 offen lds
    v_and_b32 v2, 31, v0
    v_lshrrev_b32 v3, 5, v0
    v_bfe_u32 v4, v2, 2, 1
    v_lshlrev_b32 v4, 4, v4
    v_lshrrev_b32 v5, 3, v2
    v_lshl_add_u32 v4, v5, 2, v4
    v_and_b32 v5, 3, v2
    v_add_u32 v16, v4, v5
    v_bfe_u32 v5, v16, 1, 3
    v_xor_b32 v5, v3, v5
    v_lshlrev_b32 v6, 7, v16
    v_lshl_add_u32 v6, v5, 4, v6
    s_lshl_b32 s90, s4, 12
    v_add_u32 v6, s90, v6
    v_xor_b32 v28, 0, v6
    v_xor_b32 v29, 32, v6
    v_xor_b32 v30, 64, v6
    v_xor_b32 v31, 96, v6
    v_bfe_u32 v2, v0, 4, 1
    v_lshrrev_b32 v3, 5, v0
    v_bfe_u32 v4, v0, 2, 2
    v_and_b32 v5, 3, v0
    v_lshl_add_u32 v6, v3, 3, v4
    v_lshlrev_b32 v7, 6, v6
    v_lshl_add_u32 v7, v5, 3, v7
    v_lshl_add_u32 v7, v2, 12, v7
    v_lshl_add_u32 v36, v2, 5, v7
    v_xor_b32 v37, 32, v36
    s_and_b32 s90, s7, 1
    s_lshl_b32 s90, s90, 5
    v_xor_b32 v25, s90, v36
    v_lshlrev_b32 v7, 7, v6
    v_lshl_add_u32 v7, v5, 3, v7
    v_lshl_add_u32 v7, v2, 13, v7
    v_bfe_u32 v8, v4, 1, 1
    v_lshl_or_b32 v8, v2, 1, v8
    v_lshl_add_u32 v7, v8, 5, v7
    s_lshl_b32 s90, s5, 6
    v_xor_b32 v38, s90, v7
    v_xor_b32 v39, 32, v38
    v_and_b32 v2, 31, v0
    v_lshrrev_b32 v3, 5, v0
    v_bfe_u32 v5, v2, 1, 3
    v_xor_b32 v5, v3, v5
    v_lshlrev_b32 v6, 7, v2
    v_lshl_add_u32 v6, v5, 4, v6
    v_xor_b32 v32, 0, v6
    v_xor_b32 v33, 32, v6
    v_xor_b32 v34, 64, v6
    v_xor_b32 v35, 96, v6
    s_waitcnt vmcnt(11)
    s_mov_b32 s90, 0x3f803f80
    v_mov_b32 v2, 0
    v_mov_b32 v3, 0
    v_dot2_f32_bf16 v2, v48, s90, v2
    v_dot2_f32_bf16 v3, v48, v48, v3
    v_dot2_f32_bf16 v2, v49, s90, v2
    v_dot2_f32_bf16 v3, v49, v49, v3
    v_dot2_f32_bf16 v2, v50, s90, v2
    v_dot2_f32_bf16 v3, v50, v50, v3
    v_dot2_f32_bf16 v2, v51, s90, v2
    v_dot2_f32_bf16 v3, v51, v51, v3
    s_nop 2
    v_add_f32_dpp v2, v2, v2 row_shr:1 row_mask:0xf bank_mask:0xf
    v_add_f32_dpp v3, v3, v3 row_shr:1 row_mask:0xf bank_mask:0xf
    s_nop 1
    v_add_f32_dpp v2, v2, v2 row_shr:2 row_mask:0xf bank_mask:0xf
    v_add_f32_dpp v3, v3, v3 row_shr:2 row_mask:0xf bank_mask:0xf
    s_nop 1
    v_add_f32_dpp v2, v2, v2 row_shr:4 row_mask:0xf bank_mask:0xf
    v_add_f32_dpp v3, v3, v3 row_shr:4 row_mask:0xf bank_mask:0xf
    s_nop 1
    v_add_f32_dpp v2, v2, v2 row_shr:8 row_mask:0xf bank_mask:0xf
    v_add_f32_dpp v3, v3, v3 row_shr:8 row_mask:0xf bank_mask:0xf
    s_nop 1
    v_add_f32_dpp v2, v2, v2 row_bcast:15 row_mask:0xa bank_mask:0xf
    v_add_f32_dpp v3, v3, v3 row_bcast:15 row_mask:0xa bank_mask:0xf
    s_nop 1
    v_add_f32_dpp v2, v2, v2 row_bcast:31 row_mask:0xc bank_mask:0xf
    v_add_f32_dpp v3, v3, v3 row_bcast:31 row_mask:0xc bank_mask:0xf
    s_nop 1
    v_mul_f32 v2, 0x3b000000, v2
    v_mul_f32 v3, 0x3b000000, v3
    v_fma_f32 v3, -v2, v2, v3
    v_max_f32 v3, 0, v3
    v_cvt_pk_bf16_f32 v4, v2, v3
    v_and_b32 v5, 0xffff0000, v4
    v_add_f32 v5, 0x3727c5ac, v5
    v_cvt_pk_bf16_f32 v5, v5, v5
    v_lshlrev_b32 v5, 16, v5
    v_sqrt_f32 v5, v5
    s_nop 0
    v_cvt_pk_bf16_f32 v8, v2, v5
    s_cmp_lg_u32 s3, 7
    s_cbranch_scc1 K1_NN2
K1_NLOOP:
    v_readfirstlane_b32 s70, v12
    s_cmp_lg_u32 s70, 0
    s_cbranch_scc1 K1_NGOT
    v_mov_b32 v7, 0
    global_load_dword v12, v7, s[64:65] sc1
    s_waitcnt vmcnt(0)
    s_add_u32 s32, s32, 1
    s_cmp_lt_u32 s32, 20000
    s_cbranch_scc1 K1_NLOOP
K1_NGOT:
    v_mov_b32 v7, 155648
    ds_write_b32 v7, v12
    s_waitcnt lgkmcnt(0)
K1_NN2:
    s_waitcnt vmcnt(4)
    s_barrier
    v_mov_b32 v7, 155648
    ds_read_b32 v6, v7
    s_waitcnt lgkmcnt(0)
    v_readfirstlane_b32 s70, v6
    s_lshl_b32 s90, s6, 7
    s_lshl_b32 s91, s7, 3
    s_add_u32 s90, s90, s91
    s_add_u32 s90, s90, s3
    s_lshl_b32 s90, s90, 3
    v_mov_b32 v9, s70
    v_mov_b32 v7, 0
    s_mov_b32 exec_lo, 0
    s_brev_b32 exec_hi, 1
    buffer_store_dwordx2 v[8:9], v7, s[24:27], s90 offen offset:0 sc0 sc1
    s_mov_b64 exec, -1
    s_cmp_lg_u32 s5, 0
    s_cbranch_scc1 K1_CH1
K1_CH0:
    s_lshl_b32 s68, s6, 2
    s_add_u32 s68, s68, s4
    s_mul_i32 s68, s68, 180224
    s_mul_i32 s69, s7, 9
    s_lshl_b32 s69, s69, 10
    s_add_u32 s69, s69, 16384
    s_lshl_b32 s71, s6, 7
    s_lshl_b32 s90, s4, 5
    s_add_u32 s71, s71, s90
    s_lshl_b32 s71, s71, 3
    ds_read_b128 v[128:131], v28 offset:0
    ds_read_b128 v[40:43], v32 offset:16384
    ds_read_b128 v[44:47], v32 offset:20480
    ds_read_b128 v[132:135], v29 offset:0
    ds_read_b128 v[48:51], v33 offset:16384
    ds_read_b128 v[52:55], v33 offset:20480
    s_waitcnt lgkmcnt(3)
    v_mfma_f32_32x32x16_bf16 v[64:79], v[128:131], v[40:43], 0
    s_add_u32 m0, s76, 65536
    s_add_u32 s84, s78, s38
    buffer_load_dwordx4 v20, s[8:11], s84 offen lds
    ds_read_b128 v[136:139], v30 offset:0
    ds_read_b128 v[40:43], v34 offset:16384
    v_mfma_f32_32x32x16_bf16 v[80:95], v[128:131], v[44:47], 0
    s_add_u32 m0, s76, 66560
    s_add_u32 s84, s78, s38
    buffer_load_dwordx4 v21, s[8:11], s84 offen lds
    ds_read_b128 v[44:47], v34 offset:20480
    s_waitcnt lgkmcnt(3)
    v_mfma_f32_32x32x16_bf16 v[64:79], v[132:135], v[48:51], v[64:79]
    s_add_u32 m0, s75, 81920
    s_mov_b32 s84, s38
    buffer_load_dwordx4 v22, s[12:15], s84 offen lds
    ds_read_b128 v[140:143], v31 offset:0
    ds_read_b128 v[48:51], v35 offset:16384
    v_mfma_f32_32x32x16_bf16 v[80:95], v[132:135], v[52:55], v[80:95]
    s_add_u32 m0, s75, 90112
    s_add_u32 s84, s80, s52
    buffer_load_dwordx4 v23, s[16:19], s84 offen lds
    ds_read_b128 v[52:55], v35 offset:20480
    s_waitcnt lgkmcnt(3)
    v_mfma_f32_32x32x16_bf16 v[64:79], v[136:139], v[40:43], v[64:79]
    s_add_u32 m0, s76, 98304
    s_add_u32 s84, s78, s39
    buffer_load_dwordx4 v20, s[8:11], s84 offen lds
    s_add_u32 m0, s76, 99328
    s_add_u32 s84, s78, s39
    buffer_load_dwordx4 v21, s[8:11], s84 offen lds
    s_add_u32 m0, s75, 114688
    s_mov_b32 s84, s39
    buffer_load_dwordx4 v22, s[12:15], s84 offen lds
    s_add_u32 m0, s75, 122880
    s_add_u32 s84, s80, s53
    buffer_load_dwordx4 v23, s[16:19], s84 offen lds
    s_cmp_eq_u32 s88, 0
    s_cbranch_scc1 K1_MINI0_C0
    s_mul_i32 s91, s89, 458752
    s_cmp_eq_u32 s88, 1
    s_cbranch_scc1 K1_MINI1_C0
    s_sub_u32 s90, s88, 2
    s_lshl_b32 s90, s90, 6
    s_add_u32 s90, s90, s81
    s_add_u32 s90, s90, s91
    s_add_u32 m0, s75, 131072
    s_add_u32 s84, s90, 0
    buffer_load_dwordx4 v23, s[16:19], s84 offen lds
    s_add_u32 m0, s75, 139264
    s_add_u32 s84, s90, 229376
    buffer_load_dwordx4 v23, s[16:19], s84 offen lds
    s_branch K1_MINIDONE_C0
K1_MINI1_C0:
    s_add_u32 s90, s80, s91
    s_add_u32 m0, s75, 131072
    s_add_u32 s84, s90, 0
    buffer_load_dwordx4 v23, s[16:19], s84 offen lds
    s_add_u32 m0, s75, 139264
    s_add_u32 s84, s90, 229376
    buffer_load_dwordx4 v23, s[16:19], s84 offen lds
    s_add_u32 s90, s79, s91
    v_lshrrev_b32 v2, 1, v0
    s_lshl_b32 s91, s4, 5
    v_add_u32 v2, s91, v2
    s_movk_i32 s91, 3584
    v_mul_lo_u32 v2, v2, s91
    v_and_b32 v3, 1, v0
    v_lshl_add_u32 v2, v3, 4, v2
    s_add_u32 m0, s75, 147456
    s_add_u32 s84, s90, 0
    buffer_load_dwordx4 v2, s[16:19], s84 offen lds
    s_branch K1_MINIDONE_C0
K1_MINI0_C0:
    s_lshl_b32 s90, s89, 8
    s_add_u32 m0, s75, 131072
    s_add_u32 s84, s90, 0
    buffer_load_dwordx4 v22, s[12:15], s84 offen lds
    s_add_u32 m0, s75, 139264
    s_add_u32 s84, s90, 128
    buffer_load_dwordx4 v22, s[12:15], s84 offen lds
K1_MINIDONE_C0:
    s_waitcnt vmcnt(9)
    s_waitcnt lgkmcnt(0)
    s_barrier
    v_add_u32 v28, 32768, v28
    v_add_u32 v29, 32768, v29
    v_add_u32 v30, 32768, v30
    v_add_u32 v31, 32768, v31
    ds_read_b128 v[144:147], v28 offset:0
    v_add_u32 v32, 32768, v32
    v_add_u32 v33, 32768, v33
    v_add_u32 v34, 32768, v34
    v_add_u32 v35, 32768, v35
    ds_read_b128 v[40:43], v32 offset:16384
    v_mfma_f32_32x32x16_bf16 v[80:95], v[136:139], v[44:47], v[80:95]
    s_add_u32 m0, s76, 0
    s_add_u32 s84, s78, s40
    buffer_load_dwordx4 v20, s[8:11], s84 offen lds
    ds_read_b128 v[44:47], v32 offset:20480
    v_mfma_f32_32x32x16_bf16 v[64:79], v[140:143], v[48:51], v[64:79]
    s_add_u32 m0, s76, 1024
    s_add_u32 s84, s78, s40
    buffer_load_dwordx4 v21, s[8:11], s84 offen lds
    ds_read_b128 v[148:151], v29 offset:0
    ds_read_b128 v[48:51], v33 offset:16384
    v_mfma_f32_32x32x16_bf16 v[80:95], v[140:143], v[52:55], v[80:95]
    s_add_u32 m0, s75, 16384
    s_mov_b32 s84, s40
    buffer_load_dwordx4 v22, s[12:15], s84 offen lds
    ds_read_b128 v[52:55], v33 offset:20480
    s_waitcnt lgkmcnt(3)
    v_mfma_f32_32x32x16_bf16 v[64:79], v[144:147], v[40:43], v[64:79]
    s_add_u32 m0, s75, 24576
    s_add_u32 s84, s80, s54
    buffer_load_dwordx4 v23, s[16:19], s84 offen lds
    ds_read_b128 v[152:155], v30 offset:0
    ds_read_b128 v[40:43], v34 offset:16384
    v_mfma_f32_32x32x16_bf16 v[80:95], v[144:147], v[44:47], v[80:95]
    ds_read_b128 v[44:47], v34 offset:20480
    s_waitcnt lgkmcnt(3)
    v_mfma_f32_32x32x16_bf16 v[64:79], v[148:151], v[48:51], v[64:79]
    ds_read_b128 v[156:159], v31 offset:0
    ds_read_b128 v[48:51], v35 offset:16384
    v_mfma_f32_32x32x16_bf16 v[80:95], v[148:151], v[52:55], v[80:95]
    ds_read_b128 v[52:55], v35 offset:20480
    s_waitcnt lgkmcnt(3)
    v_mfma_f32_32x32x16_bf16 v[64:79], v[152:155], v[40:43], v[64:79]
    s_waitcnt vmcnt(8)
    s_waitcnt vmcnt(4)
    s_waitcnt lgkmcnt(0)
    s_barrier
    s_cmp_eq_u32 s88, 1
    s_cselect_b32 s90, 3, 2
    s_cmp_ge_u32 s3, s90
    s_cbranch_scc1 K1_MCDONE
    v_mov_b32 v2, 0x3f803f80
    v_mov_b32 v3, 0x3f803f80
    v_mov_b32 v4, 0x3f803f80
    v_mov_b32 v5, 0x3f803f80
    s_cmp_eq_u32 s88, 0
    s_cbranch_scc1 K1_MC0
    s_cmp_eq_u32 s3, 2
    s_cbranch_scc1 K1_MC1N
    s_lshl_b32 s90, s3, 5
    v_xor_b32 v6, s90, v36
    v_add_u32 v6, 131072, v6
    ds_read_b64_tr_b16 v[96:97], v6 offset:0
    ds_read_b64_tr_b16 v[98:99], v6 offset:256
    ds_read_b64_tr_b16 v[100:101], v6 offset:1024
    ds_read_b64_tr_b16 v[102:103], v6 offset:1280
    ds_read_b64_tr_b16 v[104:105], v6 offset:2048
    ds_read_b64_tr_b16 v[106:107], v6 offset:2304
    ds_read_b64_tr_b16 v[108:109], v6 offset:3072
    ds_read_b64_tr_b16 v[110:111], v6 offset:3328
    s_waitcnt lgkmcnt(0)
    v_mfma_f32_32x32x16_bf16 v[112:127], v[2:5], v[96:99], 0
    v_mfma_f32_32x32x16_bf16 v[112:127], v[2:5], v[100:103], v[112:127]
    v_mfma_f32_32x32x16_bf16 v[112:127], v[2:5], v[104:107], v[112:127]
    v_mfma_f32_32x32x16_bf16 v[112:127], v[2:5], v[108:111], v[112:127]
    ds_read_b64_tr_b16 v[96:97], v6 offset:8192
    ds_read_b64_tr_b16 v[98:99], v6 offset:8448
    ds_read_b64_tr_b16 v[100:101], v6 offset:9216
    ds_read_b64_tr_b16 v[102:103], v6 offset:9472
    ds_read_b64_tr_b16 v[104:105], v6 offset:10240
    ds_read_b64_tr_b16 v[106:107], v6 offset:10496
    ds_read_b64_tr_b16 v[108:109], v6 offset:11264
    ds_read_b64_tr_b16 v[110:111], v6 offset:11520
    s_waitcnt lgkmcnt(0)
    v_mfma_f32_32x32x16_bf16 v[112:127], v[2:5], v[96:99], v[112:127]
    v_mfma_f32_32x32x16_bf16 v[112:127], v[2:5], v[100:103], v[112:127]
    v_mfma_f32_32x32x16_bf16 v[112:127], v[2:5], v[104:107], v[112:127]
    v_mfma_f32_32x32x16_bf16 v[112:127], v[2:5], v[108:111], v[112:127]
    s_branch K1_MCM
K1_MC1N:
    v_bfe_u32 v6, v0, 4, 1
    v_lshlrev_b32 v6, 12, v6
    v_lshrrev_b32 v7, 5, v0
    v_bfe_u32 v8, v0, 2, 2
    v_lshl_add_u32 v7, v7, 3, v8
    v_lshl_add_u32 v6, v7, 5, v6
    v_and_b32 v7, 3, v0
    v_lshl_add_u32 v6, v7, 3, v6
    v_add_u32 v6, 147456, v6
    ds_read_b64_tr_b16 v[96:97], v6 offset:0
    ds_read_b64_tr_b16 v[98:99], v6 offset:128
    ds_read_b64_tr_b16 v[100:101], v6 offset:512
    ds_read_b64_tr_b16 v[102:103], v6 offset:640
    ds_read_b64_tr_b16 v[104:105], v6 offset:1024
    ds_read_b64_tr_b16 v[106:107], v6 offset:1152
    ds_read_b64_tr_b16 v[108:109], v6 offset:1536
    ds_read_b64_tr_b16 v[110:111], v6 offset:1664
    s_waitcnt lgkmcnt(0)
    v_mfma_f32_32x32x16_bf16 v[112:127], v[2:5], v[96:99], 0
    v_mfma_f32_32x32x16_bf16 v[112:127], v[2:5], v[100:103], v[112:127]
    v_mfma_f32_32x32x16_bf16 v[112:127], v[2:5], v[104:107], v[112:127]
    v_mfma_f32_32x32x16_bf16 v[112:127], v[2:5], v[108:111], v[112:127]
    ds_read_b64_tr_b16 v[96:97], v6 offset:2048
    ds_read_b64_tr_b16 v[98:99], v6 offset:2176
    ds_read_b64_tr_b16 v[100:101], v6 offset:2560
    ds_read_b64_tr_b16 v[102:103], v6 offset:2688
    ds_read_b64_tr_b16 v[104:105], v6 offset:3072
    ds_read_b64_tr_b16 v[106:107], v6 offset:3200
    ds_read_b64_tr_b16 v[108:109], v6 offset:3584
    ds_read_b64_tr_b16 v[110:111], v6 offset:3712
    s_waitcnt lgkmcnt(0)
    v_mfma_f32_32x32x16_bf16 v[112:127], v[2:5], v[96:99], v[112:127]
    v_mfma_f32_32x32x16_bf16 v[112:127], v[2:5], v[100:103], v[112:127]
    v_mfma_f32_32x32x16_bf16 v[112:127], v[2:5], v[104:107], v[112:127]
    v_mfma_f32_32x32x16_bf16 v[112:127], v[2:5], v[108:111], v[112:127]
    s_branch K1_MCM
K1_MC0:
    s_lshl_b32 s90, s3, 12
    s_add_u32 s90, s90, 98304
    v_add_u32 v6, s90, v32
    ds_read_b128 v[96:99], v6 offset:0
    v_add_u32 v6, s90, v33
    ds_read_b128 v[100:103], v6 offset:0
    v_add_u32 v6, s90, v34
    ds_read_b128 v[104:107], v6 offset:0
    v_add_u32 v6, s90, v35
    ds_read_b128 v[108:111], v6 offset:0
    s_waitcnt lgkmcnt(0)
    v_mfma_f32_32x32x16_bf16 v[112:127], v[2:5], v[96:99], 0
    v_mfma_f32_32x32x16_bf16 v[112:127], v[2:5], v[100:103], v[112:127]
    v_mfma_f32_32x32x16_bf16 v[112:127], v[2:5], v[104:107], v[112:127]
    v_mfma_f32_32x32x16_bf16 v[112:127], v[2:5], v[108:111], v[112:127]
    v_add_u32 v6, s90, v32
    ds_read_b128 v[96:99], v6 offset:8192
    v_add_u32 v6, s90, v33
    ds_read_b128 v[100:103], v6 offset:8192
    v_add_u32 v6, s90, v34
    ds_read_b128 v[104:107], v6 offset:8192
    v_add_u32 v6, s90, v35
    ds_read_b128 v[108:111], v6 offset:8192
    s_waitcnt lgkmcnt(0)
    v_mfma_f32_32x32x16_bf16 v[112:127], v[2:5], v[96:99], v[112:127]
    v_mfma_f32_32x32x16_bf16 v[112:127], v[2:5], v[100:103], v[112:127]
    v_mfma_f32_32x32x16_bf16 v[112:127], v[2:5], v[104:107], v[112:127]
    v_mfma_f32_32x32x16_bf16 v[112:127], v[2:5], v[108:111], v[112:127]
K1_MCM:
    s_nop 15
    s_nop 3
    s_lshl_b32 s90, s88, 1
    s_add_u32 s90, s90, s3
    s_cmp_eq_u32 s3, 2
    s_cselect_b32 s90, 8, s90
    s_mul_i32 s91, s7, 9
    s_add_u32 s90, s90, s91
    s_lshl_b32 s90, s90, 10
    s_lshr_b32 s91, s89, 1
    s_lshl_b32 s91, s91, 9
    s_add_u32 s90, s90, s91
    s_and_b32 s91, s89, 1
    s_lshl_b32 s91, s91, 3
    s_add_u32 s90, s90, s91
    v_mov_b32 v4, v112
    v_mov_b32 v5, s70
    s_add_u32 s90, s90, 16384
    s_mov_b32 exec_hi, 0
    buffer_store_dwordx2 v[4:5], v27, s[24:27], s90 offen sc0 sc1
    s_mov_b64 exec, -1
K1_MCDONE:
    v_add_u32 v28, 32768, v28
    v_add_u32 v29, 32768, v29
    v_add_u32 v30, 32768, v30
    v_add_u32 v31, 32768, v31
    ds_read_b128 v[160:163], v28 offset:0
    v_add_u32 v32, 32768, v32
    v_add_u32 v33, 32768, v33
    v_add_u32 v34, 32768, v34
    v_add_u32 v35, 32768, v35
    ds_read_b128 v[40:43], v32 offset:16384
    v_mfma_f32_32x32x16_bf16 v[80:95], v[152:155], v[44:47], v[80:95]
    s_add_u32 m0, s76, 32768
    s_add_u32 s84, s78, s41
    buffer_load_dwordx4 v20, s[8:11], s84 offen lds
    ds_read_b128 v[44:47], v32 offset:20480
    v_mfma_f32_32x32x16_bf16 v[64:79], v[156:159], v[48:51], v[64:79]
    s_add_u32 m0, s76, 33792
    s_add_u32 s84, s78, s41
    buffer_load_dwordx4 v21, s[8:11], s84 offen lds
    ds_read_b128 v[164:167], v29 offset:0
    ds_read_b128 v[48:51], v33 offset:16384
    v_mfma_f32_32x32x16_bf16 v[80:95], v[156:159], v[52:55], v[80:95]
    s_add_u32 m0, s75, 49152
    s_mov_b32 s84, s41
    buffer_load_dwordx4 v22, s[12:15], s84 offen lds
    ds_read_b128 v[52:55], v33 offset:20480
    s_waitcnt lgkmcnt(3)
    v_mfma_f32_32x32x16_bf16 v[64:79], v[160:163], v[40:43], v[64:79]
    s_add_u32 m0, s75, 57344
    s_add_u32 s84, s80, s55
    buffer_load_dwordx4 v23, s[16:19], s84 offen lds
    ds_read_b128 v[168:171], v30 offset:0
    ds_read_b128 v[40:43], v34 offset:16384
    v_mfma_f32_32x32x16_bf16 v[80:95], v[160:163], v[44:47], v[80:95]
    ds_read_b128 v[44:47], v34 offset:20480
    s_waitcnt lgkmcnt(3)
    v_mfma_f32_32x32x16_bf16 v[64:79], v[164:167], v[48:51], v[64:79]
    ds_read_b128 v[172:175], v31 offset:0
    ds_read_b128 v[48:51], v35 offset:16384
    v_mfma_f32_32x32x16_bf16 v[80:95], v[164:167], v[52:55], v[80:95]
    ds_read_b128 v[52:55], v35 offset:20480
    s_waitcnt lgkmcnt(3)
    v_mfma_f32_32x32x16_bf16 v[64:79], v[168:171], v[40:43], v[64:79]
    s_waitcnt lgkmcnt(0)
    s_barrier
    v_add_u32 v28, 32768, v28
    v_add_u32 v29, 32768, v29
    v_add_u32 v30, 32768, v30
    v_add_u32 v31, 32768, v31
    ds_read_b128 v[176:179], v28 offset:0
    v_add_u32 v32, 32768, v32
    v_add_u32 v33, 32768, v33
    v_add_u32 v34, 32768, v34
    v_add_u32 v35, 32768, v35
    ds_read_b128 v[40:43], v32 offset:16384
    v_mfma_f32_32x32x16_bf16 v[80:95], v[168:171], v[44:47], v[80:95]
    s_add_u32 m0, s76, 65536
    s_add_u32 s84, s78, s42
    buffer_load_dwordx4 v20, s[8:11], s84 offen lds
    v_lshlrev_b32 v2, 16, v1
    v_lshlrev_b32 v3, 16, v18
    v_lshlrev_b32 v4, 16, v19
    v_mul_f32 v4, 0x3fb8aa3b, v4
    v_exp_f32 v4, v4
    s_nop 0
    v_cvt_pk_bf16_f32 v4, v4, v4
    ds_read_b128 v[44:47], v32 offset:20480
    v_mfma_f32_32x32x16_bf16 v[64:79], v[172:175], v[48:51], v[64:79]
    s_add_u32 m0, s76, 66560
    s_add_u32 s84, s78, s42
    buffer_load_dwordx4 v21, s[8:11], s84 offen lds
    v_lshlrev_b32 v4, 16, v4
    v_mul_f32 v5, v4, v2
    v_mul_f32 v6, v4, v3
    v_mul_f32 v5, 0x3fb8aa3b, v5
    v_mul_f32 v6, 0x3e22f983, v6
    v_exp_f32 v5, v5
    v_fract_f32 v6, v6
    s_nop 0
    ds_read_b128 v[180:183], v29 offset:0
    ds_read_b128 v[48:51], v33 offset:16384
    v_mfma_f32_32x32x16_bf16 v[80:95], v[172:175], v[52:55], v[80:95]
    s_add_u32 m0, s75, 81920
    s_mov_b32 s84, s42
    buffer_load_dwordx4 v22, s[12:15], s84 offen lds
    v_cos_f32 v7, v6
    v_sin_f32 v8, v6
    s_nop 0
    v_mul_f32 v56, v5, v7
    v_mul_f32 v57, v5, v8
    v_subrev_f32 v7, 1.0, v56
    v_mul_f32 v9, v2, v2
    v_fma_f32 v9, v3, v3, v9
    ds_read_b128 v[52:55], v33 offset:20480
    s_waitcnt lgkmcnt(3)
    v_mfma_f32_32x32x16_bf16 v[64:79], v[176:179], v[40:43], v[64:79]
    s_add_u32 m0, s75, 90112
    s_add_u32 s84, s80, s56
    buffer_load_dwordx4 v23, s[16:19], s84 offen lds
    v_rcp_f32 v9, v9
    v_mul_f32 v10, v7, v2
    v_fma_f32 v10, v57, v3, v10
    v_mul_f32 v11, v57, v2
    v_fma_f32 v11, -v7, v3, v11
    v_add_f32 v9, v9, v9
    v_mul_f32 v62, v10, v9
    v_mul_f32 v63, v11, v9
    ds_read_b128 v[184:187], v30 offset:0
    ds_read_b128 v[40:43], v34 offset:16384
    v_mfma_f32_32x32x16_bf16 v[80:95], v[176:179], v[44:47], v[80:95]
    v_mul_f32 v2, v56, v56
    v_mul_f32 v3, v56, v57
    v_fma_f32 v58, -v57, v57, v2
    v_add_f32 v59, v3, v3
    v_mul_f32 v2, v58, v58
    v_mul_f32 v3, v58, v59
    v_fma_f32 v58, -v59, v59, v2
    v_add_f32 v59, v3, v3
    ds_read_b128 v[44:47], v34 offset:20480
    s_waitcnt lgkmcnt(3)
    v_mfma_f32_32x32x16_bf16 v[64:79], v[180:183], v[48:51], v[64:79]
    v_mul_f32 v2, v58, v58
    v_mul_f32 v3, v58, v59
    v_fma_f32 v58, -v59, v59, v2
    v_add_f32 v59, v3, v3
    v_mul_f32 v2, v58, v58
    v_mul_f32 v3, v58, v59
    v_fma_f32 v58, -v59, v59, v2
    v_add_f32 v59, v3, v3
    ds_read_b128 v[188:191], v31 offset:0
    ds_read_b128 v[48:51], v35 offset:16384
    v_mfma_f32_32x32x16_bf16 v[80:95], v[180:183], v[52:55], v[80:95]
    v_mul_f32 v2, v58, v58
    v_mul_f32 v3, v58, v59
    v_fma_f32 v60, -v59, v59, v2
    v_add_f32 v61, v3, v3
    v_mul_f32 v2, v60, v60
    v_mul_f32 v3, v60, v61
    v_fma_f32 v60, -v61, v61, v2
    v_add_f32 v61, v3, v3
    ds_read_b128 v[52:55], v35 offset:20480
    s_waitcnt lgkmcnt(3)
    v_mfma_f32_32x32x16_bf16 v[64:79], v[184:187], v[40:43], v[64:79]
    v_mul_f32 v2, v60, v60
    v_mul_f32 v3, v60, v61
    v_fma_f32 v60, -v61, v61, v2
    v_add_f32 v61, v3, v3
    v_mul_f32 v4, v58, v58
    v_mul_f32 v5, v58, v59
    v_fma_f32 v2, -v59, v59, v4
    v_add_f32 v3, v5, v5
    s_waitcnt vmcnt(8)
    s_waitcnt lgkmcnt(0)
    s_barrier
    v_subrev_u32 v28, 98304, v28
    v_subrev_u32 v29, 98304, v29
    v_subrev_u32 v30, 98304, v30
    v_subrev_u32 v31, 98304, v31
    ds_read_b128 v[192:195], v28 offset:0
    v_subrev_u32 v32, 98304, v32
    v_subrev_u32 v33, 98304, v33
    v_subrev_u32 v34, 98304, v34
    v_subrev_u32 v35, 98304, v35
    ds_read_b128 v[40:43], v32 offset:16384
    v_mfma_f32_32x32x16_bf16 v[80:95], v[184:187], v[44:47], v[80:95]
    s_add_u32 m0, s76, 98304
    s_add_u32 s84, s78, s43
    buffer_load_dwordx4 v20, s[8:11], s84 offen lds
    v_mul_f32 v4, v2, v2
    v_mul_f32 v5, v2, v3
    v_fma_f32 v6, -v3, v3, v4
    v_add_f32 v7, v5, v5
    v_mul_f32 v8, v2, v6
    v_mul_f32 v9, v2, v7
    v_fma_f32 v8, -v3, v7, v8
    v_fma_f32 v9, v3, v6, v9
    ds_read_b128 v[44:47], v32 offset:20480
    v_mfma_f32_32x32x16_bf16 v[64:79], v[188:191], v[48:51], v[64:79]
    s_add_u32 m0, s76, 99328
    s_add_u32 s84, s78, s43
    buffer_load_dwordx4 v21, s[8:11], s84 offen lds
    s_cmp_eq_u32 s4, 1
    s_cselect_b64 s[92:93], -1, 0
    v_mov_b32 v10, 1.0
    v_mov_b32 v11, 0
    v_cndmask_b32 v10, v10, v2, s[92:93]
    v_cndmask_b32 v11, v11, v3, s[92:93]
    s_cmp_eq_u32 s4, 2
    s_cselect_b64 s[92:93], -1, 0
    v_cndmask_b32 v10, v10, v6, s[92:93]
    v_cndmask_b32 v11, v11, v7, s[92:93]
    ds_read_b128 v[196:199], v29 offset:0
    ds_read_b128 v[48:51], v33 offset:16384
    v_mfma_f32_32x32x16_bf16 v[80:95], v[188:191], v[52:55], v[80:95]
    s_add_u32 m0, s75, 114688
    s_mov_b32 s84, s43
    buffer_load_dwordx4 v22, s[12:15], s84 offen lds
    s_cmp_eq_u32 s4, 3
    s_cselect_b64 s[92:93], -1, 0
    v_cndmask_b32 v10, v10, v8, s[92:93]
    v_cndmask_b32 v11, v11, v9, s[92:93]
    v_mul_f32 v2, v58, v10
    v_mul_f32 v3, v58, v11
    v_fma_f32 v2, -v59, v11, v2
    v_fma_f32 v3, v59, v10, v3
    v_cmp_lt_u32 vcc, 31, v0
    ds_read_b128 v[52:55], v33 offset:20480
    s_waitcnt lgkmcnt(3)
    v_mfma_f32_32x32x16_bf16 v[64:79], v[192:195], v[40:43], v[64:79]
    s_add_u32 m0, s75, 122880
    s_add_u32 s84, s80, s57
    buffer_load_dwordx4 v23, s[16:19], s84 offen lds
    s_nop 1
    v_cndmask_b32 v1, v10, v2, vcc
    v_cndmask_b32 v18, v11, v3, vcc
    ds_read_b128 v[200:203], v30 offset:0
    ds_read_b128 v[40:43], v34 offset:16384
    v_mfma_f32_32x32x16_bf16 v[80:95], v[192:195], v[44:47], v[80:95]
    ds_read_b128 v[44:47], v34 offset:20480
    s_waitcnt lgkmcnt(3)
    v_mfma_f32_32x32x16_bf16 v[64:79], v[196:199], v[48:51], v[64:79]
    ds_read_b128 v[204:207], v31 offset:0
    ds_read_b128 v[48:51], v35 offset:16384
    v_mfma_f32_32x32x16_bf16 v[80:95], v[196:199], v[52:55], v[80:95]
    ds_read_b128 v[52:55], v35 offset:20480
    s_waitcnt lgkmcnt(3)
    v_mfma_f32_32x32x16_bf16 v[64:79], v[200:203], v[40:43], v[64:79]
    s_waitcnt vmcnt(8)
    s_waitcnt lgkmcnt(0)
    s_barrier
    v_lshlrev_b32 v10, 3, v16
    buffer_load_dwordx2 v[10:11], v10, s[24:27], s71 offen offset:0 sc1
    s_add_u32 s90, s69, 0
    buffer_load_dwordx4 v[108:111], v27, s[24:27], s90 offen sc1
    s_add_u32 s90, s69, 1024
    buffer_load_dwordx4 v[112:115], v27, s[24:27], s90 offen sc1
    s_add_u32 s90, s69, 4096
    buffer_load_dwordx4 v[116:119], v27, s[24:27], s90 offen sc1
    s_add_u32 s90, s69, 5120
    buffer_load_dwordx4 v[120:123], v27, s[24:27], s90 offen sc1
    v_add_u32 v28, 32768, v28
    v_add_u32 v29, 32768, v29
    v_add_u32 v30, 32768, v30
    v_add_u32 v31, 32768, v31
    ds_read_b128 v[208:211], v28 offset:0
    v_add_u32 v32, 32768, v32
    v_add_u32 v33, 32768, v33
    v_add_u32 v34, 32768, v34
    v_add_u32 v35, 32768, v35
    ds_read_b128 v[40:43], v32 offset:16384
    v_mfma_f32_32x32x16_bf16 v[80:95], v[200:203], v[44:47], v[80:95]
    s_add_u32 m0, s75, 131072
    s_add_u32 s84, s82, s50
    buffer_load_dwordx4 v23, s[16:19], s84 offen lds
    ds_read_b128 v[44:47], v32 offset:20480
    v_mfma_f32_32x32x16_bf16 v[64:79], v[204:207], v[48:51], v[64:79]
    s_add_u32 m0, s75, 139264
    s_add_u32 s84, s82, s51
    buffer_load_dwordx4 v23, s[16:19], s84 offen lds
    ds_read_b128 v[212:215], v29 offset:0
    ds_read_b128 v[48:51], v33 offset:16384
    v_mfma_f32_32x32x16_bf16 v[80:95], v[204:207], v[52:55], v[80:95]
    s_add_u32 m0, s75, 147456
    s_add_u32 s84, s82, s52
    buffer_load_dwordx4 v23, s[16:19], s84 offen lds
    ds_read_b128 v[52:55], v33 offset:20480
    s_waitcnt lgkmcnt(3)
    v_mfma_f32_32x32x16_bf16 v[64:79], v[208:211], v[40:43], v[64:79]
    ds_read_b128 v[216:219], v30 offset:0
    ds_read_b128 v[40:43], v34 offset:16384
    v_mfma_f32_32x32x16_bf16 v[80:95], v[208:211], v[44:47], v[80:95]
    ds_read_b128 v[44:47], v34 offset:20480
    s_waitcnt lgkmcnt(3)
    v_mfma_f32_32x32x16_bf16 v[64:79], v[212:215], v[48:51], v[64:79]
    ds_read_b128 v[220:223], v31 offset:0
    ds_read_b128 v[48:51], v35 offset:16384
    v_mfma_f32_32x32x16_bf16 v[80:95], v[212:215], v[52:55], v[80:95]
    ds_read_b128 v[52:55], v35 offset:20480
    s_waitcnt lgkmcnt(3)
    v_mfma_f32_32x32x16_bf16 v[64:79], v[216:219], v[40:43], v[64:79]
    s_waitcnt vmcnt(12)
    s_waitcnt lgkmcnt(0)
    s_barrier
    v_add_u32 v28, 32768, v28
    v_add_u32 v29, 32768, v29
    v_add_u32 v30, 32768, v30
    v_add_u32 v31, 32768, v31
    ds_read_b128 v[224:227], v28 offset:0
    v_add_u32 v32, 32768, v32
    v_add_u32 v33, 32768, v33
    v_add_u32 v34, 32768, v34
    v_add_u32 v35, 32768, v35
    ds_read_b128 v[40:43], v32 offset:16384
    v_mfma_f32_32x32x16_bf16 v[80:95], v[216:219], v[44:47], v[80:95]
    s_add_u32 m0, s75, 0
    s_add_u32 s84, s82, s53
    buffer_load_dwordx4 v23, s[16:19], s84 offen lds
    s_waitcnt vmcnt(8)
    v_cmp_ne_u32 vcc, s70, v11
    s_cbranch_vccnz K1C0_ST_SLOW
K1C0_ST_OK:
    v_and_b32 v17, 0xffff0000, v10
    v_mul_f32 v21, v17, v17
    v_rcp_f32 v17, v17
    v_and_b32 v11, 0xffff, v10
    v_xor_b32 v11, 0x8000, v11
    v_cmp_gt_u32 vcc, 32, v0
    v_lshl_or_b32 v10, v11, 16, v11
    ds_read_b128 v[44:47], v32 offset:20480
    v_mfma_f32_32x32x16_bf16 v[64:79], v[220:223], v[48:51], v[64:79]
    s_add_u32 m0, s75, 8192
    s_add_u32 s84, s82, s54
    buffer_load_dwordx4 v23, s[16:19], s84 offen lds
    v_mul_f32 v20, 0xbfb8aa3b, v17
    v_cndmask_b32 v10, 0, v10, vcc
    v_cndmask_b32 v11, 0, v11, vcc
    s_waitcnt vmcnt(8)
    v_cmp_ne_u32 vcc, s70, v109
    v_cmp_ne_u32 s[90:91], s70, v111
    s_or_b64 vcc, vcc, s[90:91]
    s_cbranch_vccnz K1C0_CS0_SLOW
K1C0_CS0_OK:
    s_waitcnt vmcnt(7)
    v_cmp_ne_u32 vcc, s70, v113
    v_cmp_ne_u32 s[90:91], s70, v115
    s_or_b64 vcc, vcc, s[90:91]
    s_cbranch_vccnz K1C0_CS1_SLOW
K1C0_CS1_OK:
    s_waitcnt vmcnt(6)
    v_cmp_ne_u32 vcc, s70, v117
    v_cmp_ne_u32 s[90:91], s70, v119
    s_or_b64 vcc, vcc, s[90:91]
    s_cbranch_vccnz K1C0_CS4_SLOW
K1C0_CS4_OK:
    s_waitcnt vmcnt(5)
    v_cmp_ne_u32 vcc, s70, v121
    v_cmp_ne_u32 s[90:91], s70, v123
    s_or_b64 vcc, vcc, s[90:91]
    s_cbranch_vccnz K1C0_CS5_SLOW
K1C0_CS5_OK:
    v_add_f32 v108, v108, v110
    ds_read_b128 v[228:231], v29 offset:0
    ds_read_b128 v[48:51], v33 offset:16384
    v_mfma_f32_32x32x16_bf16 v[80:95], v[220:223], v[52:55], v[80:95]
    s_add_u32 m0, s75, 16384
    s_add_u32 s84, s82, s55
    buffer_load_dwordx4 v23, s[16:19], s84 offen lds
    v_add_f32 v112, v112, v114
    v_add_f32 v116, v116, v118
    v_add_f32 v120, v120, v122
    v_mov_b32 v109, v108
    v_mov_b32 v113, v112
    v_mov_b32 v117, v116
    v_mov_b32 v121, v120
    s_nop 1
    ds_read_b128 v[52:55], v33 offset:20480
    s_waitcnt lgkmcnt(3)
    v_mfma_f32_32x32x16_bf16 v[64:79], v[224:227], v[40:43], v[64:79]
    s_add_u32 m0, s75, 24576
    s_add_u32 s84, s82, s56
    buffer_load_dwordx4 v23, s[16:19], s84 offen lds
    v_permlane32_swap_b32 v108, v109
    v_permlane32_swap_b32 v112, v113
    v_permlane32_swap_b32 v116, v117
    v_permlane32_swap_b32 v120, v121
    s_nop 1
    v_add_f32 v110, v108, v109
    v_add_f32 v114, v112, v113
    v_add_f32 v118, v116, v117
    ds_read_b128 v[232:235], v30 offset:0
    ds_read_b128 v[40:43], v34 offset:16384
    v_mfma_f32_32x32x16_bf16 v[80:95], v[224:227], v[44:47], v[80:95]
    v_add_f32 v122, v120, v121
    v_cvt_pk_bf16_f32 v111, v110, v110
    v_cvt_pk_bf16_f32 v115, v114, v114
    v_cvt_pk_bf16_f32 v119, v118, v118
    v_cvt_pk_bf16_f32 v123, v122, v122
    v_lshlrev_b32 v111, 16, v111
    v_lshlrev_b32 v115, 16, v115
    v_lshlrev_b32 v119, 16, v119
    ds_read_b128 v[44:47], v34 offset:20480
    s_waitcnt lgkmcnt(3)
    v_mfma_f32_32x32x16_bf16 v[64:79], v[228:231], v[48:51], v[64:79]
    v_lshlrev_b32 v123, 16, v123
    v_sub_f32 v111, v110, v111
    v_sub_f32 v115, v114, v115
    v_sub_f32 v119, v118, v119
    v_sub_f32 v123, v122, v123
    v_cvt_pk_bf16_f32 v108, v110, v111
    v_cvt_pk_bf16_f32 v112, v114, v115
    v_cvt_pk_bf16_f32 v116, v118, v119
    ds_read_b128 v[236:239], v31 offset:0
    ds_read_b128 v[48:51], v35 offset:16384
    v_mfma_f32_32x32x16_bf16 v[80:95], v[228:231], v[52:55], v[80:95]
    v_cvt_pk_bf16_f32 v120, v122, v123
    v_and_b32 v110, 0xffff0000, v108
    v_and_b32 v114, 0xffff0000, v112
    v_and_b32 v118, 0xffff0000, v116
    v_and_b32 v122, 0xffff0000, v120
    v_sub_f32 v111, v111, v110
    v_sub_f32 v115, v115, v114
    v_sub_f32 v119, v119, v118
    ds_read_b128 v[52:55], v35 offset:20480
    s_waitcnt lgkmcnt(3)
    v_mfma_f32_32x32x16_bf16 v[64:79], v[232:235], v[40:43], v[64:79]
    v_sub_f32 v123, v123, v122
    v_cvt_pk_bf16_f32 v109, v111, 0
    v_cvt_pk_bf16_f32 v113, v115, 0
    v_cvt_pk_bf16_f32 v117, v119, 0
    v_cvt_pk_bf16_f32 v121, v123, 0
    v_lshlrev_b32 v2, 3, v0
    v_add_u32 v2, 158272, v2
    ds_write_b64 v2, v[108:109] offset:0
    s_waitcnt lgkmcnt(0)
    s_barrier
    v_add_u32 v28, 32768, v28
    v_add_u32 v29, 32768, v29
    v_add_u32 v30, 32768, v30
    v_add_u32 v31, 32768, v31
    ds_read_b128 v[240:243], v28 offset:0
    v_add_u32 v32, 32768, v32
    v_add_u32 v33, 32768, v33
    v_add_u32 v34, 32768, v34
    v_add_u32 v35, 32768, v35
    ds_read_b128 v[40:43], v32 offset:16384
    v_mfma_f32_32x32x16_bf16 v[80:95], v[232:235], v[44:47], v[80:95]
    s_add_u32 m0, s75, 49152
    s_add_u32 s84, s82, s57
    buffer_load_dwordx4 v23, s[16:19], s84 offen lds
    ds_write_b64 v2, v[112:113] offset:512
    ds_write_b64 v2, v[116:117] offset:1024
    ds_write_b64 v2, v[120:121] offset:1536
    s_lshl_b32 s86, s4, 7
    s_add_u32 s86, s86, 157760
    v_lshlrev_b32 v2, 2, v16
    v_add_u32 v2, s86, v2
    ds_write_b32 v2, v17
    ds_read_b128 v[44:47], v32 offset:20480
    v_mfma_f32_32x32x16_bf16 v[64:79], v[236:239], v[48:51], v[64:79]
    s_add_u32 m0, s77, 32768
    s_add_u32 s84, s81, s50
    buffer_load_dwordx4 v24, s[16:19], s84 offen lds
    s_lshl_b32 s90, s6, 4
    s_add_u32 s90, s90, s7
    s_mov_b32 s28, s60
    s_mov_b32 s29, s61
    s_mov_b32 s30, 1835008
    s_mov_b32 s31, 0x00020000
    v_and_b32 v2, 31, v0
    v_lshrrev_b32 v3, 5, v0
    ds_read_b128 v[244:247], v29 offset:0
    ds_read_b128 v[48:51], v33 offset:16384
    v_mfma_f32_32x32x16_bf16 v[80:95], v[236:239], v[52:55], v[80:95]
    s_add_u32 m0, s77, 33792
    s_add_u32 s84, s84, 28672
    buffer_load_dwordx4 v24, s[16:19], s84 offen lds
    v_lshlrev_b32 v4, 12, v3
    v_lshl_add_u32 v4, v2, 1, v4
    s_lshl_b32 s91, s4, 1
    s_add_u32 s91, s91, 0
    s_min_u32 s91, s91, 6
    s_mul_i32 s92, s90, 7
    s_add_u32 s92, s92, s91
    s_mov_b32 s93, 38347923
    ds_read_b128 v[52:55], v33 offset:20480
    s_waitcnt lgkmcnt(3)
    v_mfma_f32_32x32x16_bf16 v[64:79], v[240:243], v[40:43], v[64:79]
    s_mul_hi_u32 s93, s92, s93
    s_mul_i32 s94, s93, 112
    s_sub_u32 s94, s92, s94
    s_lshl_b32 s95, s94, 14
    s_lshl_b32 s91, s93, 6
    s_add_u32 s95, s95, s91
    buffer_load_ushort v96, v4, s[28:31], s95 offen offset:0
    buffer_load_ushort v97, v4, s[28:31], s95 offen offset:1024
    ds_read_b128 v[248:251], v30 offset:0
    ds_read_b128 v[40:43], v34 offset:16384
    v_mfma_f32_32x32x16_bf16 v[80:95], v[240:243], v[44:47], v[80:95]
    buffer_load_ushort v98, v4, s[28:31], s95 offen offset:2048
    buffer_load_ushort v99, v4, s[28:31], s95 offen offset:3072
    s_add_u32 s91, s95, 8192
    buffer_load_ushort v100, v4, s[28:31], s91 offen offset:0
    s_add_u32 s91, s95, 8192
    buffer_load_ushort v101, v4, s[28:31], s91 offen offset:1024
    s_add_u32 s91, s95, 8192
    buffer_load_ushort v102, v4, s[28:31], s91 offen offset:2048
    ds_read_b128 v[44:47], v34 offset:20480
    s_waitcnt lgkmcnt(3)
    v_mfma_f32_32x32x16_bf16 v[64:79], v[244:247], v[48:51], v[64:79]
    s_add_u32 s91, s95, 8192
    buffer_load_ushort v103, v4, s[28:31], s91 offen offset:3072
    s_mul_i32 s33, s93, 176
    s_add_u32 s33, s33, s94
    s_add_u32 s33, s33, 64
    s_lshl_b32 s33, s33, 10
    s_lshl_b32 s91, s4, 1
    s_add_u32 s91, s91, 1
    ds_read_b128 v[252:255], v31 offset:0
    ds_read_b128 v[48:51], v35 offset:16384
    v_mfma_f32_32x32x16_bf16 v[80:95], v[244:247], v[52:55], v[80:95]
    s_min_u32 s91, s91, 6
    s_mul_i32 s92, s90, 7
    s_add_u32 s92, s92, s91
    s_mov_b32 s93, 38347923
    s_mul_hi_u32 s93, s92, s93
    s_mul_i32 s94, s93, 112
    s_sub_u32 s94, s92, s94
    s_lshl_b32 s95, s94, 14
    ds_read_b128 v[52:55], v35 offset:20480
    s_waitcnt lgkmcnt(3)
    v_mfma_f32_32x32x16_bf16 v[64:79], v[248:251], v[40:43], v[64:79]
    s_lshl_b32 s91, s93, 6
    s_add_u32 s95, s95, s91
    buffer_load_ushort v104, v4, s[28:31], s95 offen offset:0
    buffer_load_ushort v105, v4, s[28:31], s95 offen offset:1024
    buffer_load_ushort v106, v4, s[28:31], s95 offen offset:2048
    buffer_load_ushort v107, v4, s[28:31], s95 offen offset:3072
    s_add_u32 s91, s95, 8192
    buffer_load_ushort v108, v4, s[28:31], s91 offen offset:0
    s_waitcnt vmcnt(16)
    s_waitcnt lgkmcnt(0)
    s_barrier
    v_mfma_f32_32x32x16_bf16 v[80:95], v[248:251], v[44:47], v[80:95]
    s_add_u32 m0, s77, 65536
    s_add_u32 s84, s81, s51
    buffer_load_dwordx4 v24, s[16:19], s84 offen lds
    s_add_u32 s91, s95, 8192
    buffer_load_ushort v109, v4, s[28:31], s91 offen offset:1024
    s_add_u32 s91, s95, 8192
    buffer_load_ushort v110, v4, s[28:31], s91 offen offset:2048
    s_add_u32 s91, s95, 8192
    buffer_load_ushort v111, v4, s[28:31], s91 offen offset:3072
    s_mul_i32 s87, s93, 176
    s_add_u32 s87, s87, s94
    v_mfma_f32_32x32x16_bf16 v[64:79], v[252:255], v[48:51], v[64:79]
    s_add_u32 m0, s77, 66560
    s_add_u32 s84, s84, 28672
    buffer_load_dwordx4 v24, s[16:19], s84 offen lds
    s_add_u32 s87, s87, 64
    s_lshl_b32 s87, s87, 10
    s_lshl_b32 s93, s90, 2
    s_add_u32 s93, s93, s4
    s_lshr_b32 s94, s93, 6
    s_and_b32 s95, s93, 63
    v_lshlrev_b32 v4, 10, v2
    v_lshl_add_u32 v4, v3, 3, v4
    v_mfma_f32_32x32x16_bf16 v[80:95], v[252:255], v[52:55], v[80:95]
    s_add_u32 m0, s77, 81920
    s_add_u32 s84, s81, s52
    buffer_load_dwordx4 v24, s[16:19], s84 offen lds
    s_lshl_b32 s91, s94, 15
    s_lshl_b32 s90, s95, 4
    s_add_u32 s91, s91, s90
    s_mov_b32 s28, s46
    s_mov_b32 s29, s47
    s_mov_b32 s30, 524288
    buffer_load_dwordx2 v[112:113], v4, s[28:31], s91 offen
    s_mov_b32 s28, s48
    s_add_u32 m0, s77, 82944
    s_add_u32 s84, s84, 28672
    buffer_load_dwordx4 v24, s[16:19], s84 offen lds
    s_mov_b32 s29, s49
    buffer_load_dwordx2 v[114:115], v4, s[28:31], s91 offen
    s_mul_i32 s85, s94, 176
    s_add_u32 s85, s85, s95
    s_lshl_b32 s85, s85, 10
    v_mov_b32 v28, v10
    v_mov_b32 v29, v11
    v_mov_b32 v30, 0
    s_add_u32 m0, s77, 98304
    s_add_u32 s84, s81, s53
    buffer_load_dwordx4 v24, s[16:19], s84 offen lds
    v_mov_b32 v31, 0
    v_mov_b32 v14, 0
    v_mov_b32 v15, 0
    s_waitcnt vmcnt(1)
    s_add_u32 s28, s66, 11534336
    s_addc_u32 s29, s67, 0
    s_mov_b32 s30, 2883584
    v_lshl_or_b32 v96, v97, 16, v96
    v_lshl_or_b32 v97, v99, 16, v98
    s_add_u32 m0, s77, 99328
    s_add_u32 s84, s84, 28672
    buffer_load_dwordx4 v24, s[16:19], s84 offen lds
    v_lshl_or_b32 v98, v101, 16, v100
    v_lshl_or_b32 v99, v103, 16, v102
    buffer_store_dwordx4 v[96:99], v27, s[28:31], s33 offen sc0 sc1
    v_lshl_or_b32 v104, v105, 16, v104
    v_lshl_or_b32 v105, v107, 16, v106
    v_lshl_or_b32 v106, v109, 16, v108
    v_lshl_or_b32 v107, v111, 16, v110
    buffer_store_dwordx4 v[104:107], v27, s[28:31], s87 offen sc0 sc1
    s_add_u32 m0, s77, 114688
    s_add_u32 s84, s81, s54
    buffer_load_dwordx4 v24, s[16:19], s84 offen lds
    s_mov_b32 s90, 0x05040100
    s_mov_b32 s91, 0x07060302
    v_perm_b32 v100, v114, v112, s90
    v_perm_b32 v101, v114, v112, s91
    v_perm_b32 v102, v115, v113, s90
    v_perm_b32 v103, v115, v113, s91
    buffer_store_dwordx4 v[100:103], v27, s[28:31], s85 offen sc0 sc1
    s_nop 1
    s_add_u32 m0, s77, 115712
    s_add_u32 s84, s84, 28672
    buffer_load_dwordx4 v24, s[16:19], s84 offen lds
    v_lshlrev_b32 v13, 3, v0
    v_add_u32 v13, 158272, v13
    ds_read_b64 v[12:13], v13 offset:0
    s_waitcnt lgkmcnt(0)
    v_mfma_f32_32x32x16_bf16 v[64:79], v[28:31], v[12:15], v[64:79]
    v_lshlrev_b32 v13, 3, v0
    v_add_u32 v13, 158272, v13
    ds_read_b64 v[12:13], v13 offset:512
    s_waitcnt lgkmcnt(0)
    v_mfma_f32_32x32x16_bf16 v[80:95], v[28:31], v[12:15], v[80:95]
    v_lshrrev_b32 v3, 5, v0
    v_lshlrev_b32 v3, 6, v3
    v_add_u32 v3, s86, v3
    ds_read_b128 v[4:7], v3 offset:0
    ds_read_b128 v[8:11], v3 offset:16
    s_waitcnt lgkmcnt(1)
    s_nop 7
    v_mul_f32 v64, v64, v4
    v_mul_f32 v80, v80, v4
    v_mul_f32 v65, v65, v5
    v_mul_f32 v81, v81, v5
    v_mul_f32 v66, v66, v6
    v_mul_f32 v82, v82, v6
    v_mul_f32 v67, v67, v7
    v_mul_f32 v83, v83, v7
    ds_read_b128 v[4:7], v3 offset:32
    s_waitcnt lgkmcnt(1)
    v_mul_f32 v68, v68, v8
    v_mul_f32 v84, v84, v8
    v_mul_f32 v69, v69, v9
    v_mul_f32 v85, v85, v9
    v_mul_f32 v70, v70, v10
    v_mul_f32 v86, v86, v10
    v_mul_f32 v71, v71, v11
    v_mul_f32 v87, v87, v11
    ds_read_b128 v[8:11], v3 offset:48
    s_waitcnt lgkmcnt(1)
    v_mul_f32 v72, v72, v4
    v_mul_f32 v88, v88, v4
    v_mul_f32 v73, v73, v5
    v_mul_f32 v89, v89, v5
    v_mul_f32 v74, v74, v6
    v_mul_f32 v90, v90, v6
    v_mul_f32 v75, v75, v7
    v_mul_f32 v91, v91, v7
    s_waitcnt lgkmcnt(0)
    v_mul_f32 v76, v76, v8
    v_mul_f32 v92, v92, v8
    v_mul_f32 v77, v77, v9
    v_mul_f32 v93, v93, v9
    v_mul_f32 v78, v78, v10
    v_mul_f32 v94, v94, v10
    v_mul_f32 v79, v79, v11
    v_mul_f32 v95, v95, v11
    v_fma_f32 v2, v56, v64, v65
    v_fma_f32 v3, v56, v80, v81
    v_fma_f32 v2, -v57, v80, v2
    v_fma_f32 v3, v57, v64, v3
    v_fma_f32 v4, v56, v2, v66
    v_fma_f32 v5, v56, v3, v82
    v_fma_f32 v4, -v57, v3, v4
    v_fma_f32 v5, v57, v2, v5
    v_fma_f32 v2, v56, v4, v67
    v_fma_f32 v3, v56, v5, v83
    v_fma_f32 v2, -v57, v5, v2
    v_fma_f32 v3, v57, v4, v3
    v_fma_f32 v4, v56, v2, v68
    v_fma_f32 v5, v56, v3, v84
    v_fma_f32 v4, -v57, v3, v4
    v_fma_f32 v5, v57, v2, v5
    v_fma_f32 v2, v56, v4, v69
    v_fma_f32 v3, v56, v5, v85
    v_fma_f32 v2, -v57, v5, v2
    v_fma_f32 v3, v57, v4, v3
    v_fma_f32 v4, v56, v2, v70
    v_fma_f32 v5, v56, v3, v86
    v_fma_f32 v4, -v57, v3, v4
    v_fma_f32 v5, v57, v2, v5
    v_fma_f32 v2, v56, v4, v71
    v_fma_f32 v3, v56, v5, v87
    v_fma_f32 v2, -v57, v5, v2
    v_fma_f32 v3, v57, v4, v3
    v_fma_f32 v4, v56, v2, v72
    v_fma_f32 v5, v56, v3, v88
    v_fma_f32 v4, -v57, v3, v4
    v_fma_f32 v5, v57, v2, v5
    v_fma_f32 v2, v56, v4, v73
    v_fma_f32 v3, v56, v5, v89
    v_fma_f32 v2, -v57, v5, v2
    v_fma_f32 v3, v57, v4, v3
    v_fma_f32 v4, v56, v2, v74
    v_fma_f32 v5, v56, v3, v90
    v_fma_f32 v4, -v57, v3, v4
    v_fma_f32 v5, v57, v2, v5
    v_fma_f32 v2, v56, v4, v75
    v_fma_f32 v3, v56, v5, v91
    v_fma_f32 v2, -v57, v5, v2
    v_fma_f32 v3, v57, v4, v3
    v_fma_f32 v4, v56, v2, v76
    v_fma_f32 v5, v56, v3, v92
    v_fma_f32 v4, -v57, v3, v4
    v_fma_f32 v5, v57, v2, v5
    v_fma_f32 v2, v56, v4, v77
    v_fma_f32 v3, v56, v5, v93
    v_fma_f32 v2, -v57, v5, v2
    v_fma_f32 v3, v57, v4, v3
    v_fma_f32 v4, v56, v2, v78
    v_fma_f32 v5, v56, v3, v94
    v_fma_f32 v4, -v57, v3, v4
    v_fma_f32 v5, v57, v2, v5
    v_fma_f32 v2, v56, v4, v79
    v_fma_f32 v3, v56, v5, v95
    v_fma_f32 v2, -v57, v5, v2
    v_fma_f32 v3, v57, v4, v3
    s_lshl_b32 s90, s4, 9
    s_add_u32 s90, s90, 155712
    v_lshlrev_b32 v6, 3, v0
    v_add_u32 v6, s90, v6
    ds_write_b64 v6, v[2:3]
    s_waitcnt vmcnt(0)
    s_waitcnt lgkmcnt(0)
    s_barrier
    s_cmp_lg_u32 s3, 0
    s_cbranch_scc1 K1_NOWTF
    s_lshl_b32 s90, s6, 4
    s_add_u32 s90, s90, s7
    s_lshl_b32 s90, s90, 4
    s_add_u32 s90, s90, 540680
    v_mov_b32 v2, s70
    v_mov_b32 v3, s70
    v_mov_b32 v4, 0
    s_mov_b64 exec, 1
    buffer_store_dwordx2 v[2:3], v4, s[24:27], s90 offen sc0 sc1
    s_mov_b64 exec, -1
K1_NOWTF:
    s_add_u32 m0, s77, 131072
    s_add_u32 s84, s81, s55
    buffer_load_dwordx4 v24, s[16:19], s84 offen lds
    v_and_b32 v6, 31, v0
    v_lshlrev_b32 v6, 3, v6
    v_add_u32 v6, 155712, v6
    ds_read_b64 v[116:117], v6 offset:0
    ds_read_b64 v[118:119], v6 offset:256
    ds_read_b64 v[120:121], v6 offset:512
    ds_read_b64 v[122:123], v6 offset:768
    ds_read_b64 v[124:125], v6 offset:1024
    ds_read_b64 v[126:127], v6 offset:1280
    s_lshl_b32 s90, s4, 9
    v_add_u32 v7, s90, v6
    ds_read_b64 v[8:9], v7
    ds_read_b64 v[10:11], v7 offset:256
    s_add_u32 m0, s77, 132096
    s_add_u32 s84, s84, 28672
    buffer_load_dwordx4 v24, s[16:19], s84 offen lds
    s_waitcnt lgkmcnt(0)
    v_mov_b32 v32, 0
    v_mov_b32 v33, 0
    s_cmp_le_u32 s4, 0
    s_cbranch_scc1 K1C0_SGD
    v_fma_f32 v2, v58, v32, v116
    v_fma_f32 v3, v58, v33, v117
    v_fma_f32 v2, -v59, v33, v2
    v_fma_f32 v33, v59, v32, v3
    v_mov_b32 v32, v2
    v_fma_f32 v2, v58, v32, v118
    v_fma_f32 v3, v58, v33, v119
    v_fma_f32 v2, -v59, v33, v2
    v_fma_f32 v33, v59, v32, v3
    v_mov_b32 v32, v2
    s_cmp_le_u32 s4, 1
    s_cbranch_scc1 K1C0_SGD
    v_fma_f32 v2, v58, v32, v120
    v_fma_f32 v3, v58, v33, v121
    v_fma_f32 v2, -v59, v33, v2
    v_fma_f32 v33, v59, v32, v3
    v_mov_b32 v32, v2
    v_fma_f32 v2, v58, v32, v122
    v_fma_f32 v3, v58, v33, v123
    v_fma_f32 v2, -v59, v33, v2
    v_fma_f32 v33, v59, v32, v3
    v_mov_b32 v32, v2
    s_cmp_le_u32 s4, 2
    s_cbranch_scc1 K1C0_SGD
    v_fma_f32 v2, v58, v32, v124
    v_fma_f32 v3, v58, v33, v125
    v_fma_f32 v2, -v59, v33, v2
    v_fma_f32 v33, v59, v32, v3
    v_mov_b32 v32, v2
    v_fma_f32 v2, v58, v32, v126
    v_fma_f32 v3, v58, v33, v127
    v_fma_f32 v2, -v59, v33, v2
    v_fma_f32 v33, v59, v32, v3
    v_mov_b32 v32, v2
K1C0_SGD:
    v_fma_f32 v2, v58, v32, v8
    v_fma_f32 v3, v58, v33, v9
    v_fma_f32 v2, -v59, v33, v2
    v_fma_f32 v3, v59, v32, v3
    v_fma_f32 v4, v58, v2, v10
    v_fma_f32 v6, v58, v3, v11
    v_fma_f32 v4, -v59, v3, v4
    v_fma_f32 v6, v59, v2, v6
    v_cmp_lt_u32 vcc, 31, v0
    v_mov_b32 v5, s70
    v_mov_b32 v7, s70
    v_cndmask_b32 v32, v32, v2, vcc
    v_cndmask_b32 v33, v33, v3, vcc
    s_lshl_b32 s90, s7, 4
    s_add_u32 s90, s90, s6
    s_lshl_b32 s90, s90, 9
    s_add_u32 s90, s90, 409600
    s_cmp_eq_u32 s4, 3
    s_cselect_b32 exec_lo, -1, 0
    s_mov_b32 exec_hi, 0
    s_cbranch_execz K1C0_NOPUB
    buffer_store_dwordx4 v[4:7], v27, s[24:27], s90 offen sc0 sc1
K1C0_NOPUB:
    s_mov_b64 exec, -1
    s_nop 1
    s_waitcnt lgkmcnt(0)
    s_barrier
    v_add_u32 v38, 32768, v38
    v_add_u32 v39, 32768, v39
    ds_read_b64_tr_b16 v[40:41], v38 offset:0
    ds_read_b64_tr_b16 v[42:43], v38 offset:512
    s_add_u32 m0, s77, 0
    s_add_u32 s84, s81, s56
    buffer_load_dwordx4 v24, s[16:19], s84 offen lds
    ds_read_b64_tr_b16 v[44:45], v38 offset:2048
    ds_read_b64_tr_b16 v[46:47], v38 offset:2560
    s_add_u32 m0, s77, 1024
    s_add_u32 s84, s84, 28672
    buffer_load_dwordx4 v24, s[16:19], s84 offen lds
    ds_read_b64_tr_b16 v[48:49], v38 offset:4096
    ds_read_b64_tr_b16 v[50:51], v38 offset:4608
    s_add_u32 m0, s77, 16384
    s_add_u32 s84, s81, s57
    buffer_load_dwordx4 v24, s[16:19], s84 offen lds
    ds_read_b64_tr_b16 v[52:53], v38 offset:6144
    ds_read_b64_tr_b16 v[54:55], v38 offset:6656
    s_waitcnt lgkmcnt(6)
    v_mfma_f32_32x32x16_bf16 v[96:111], v[40:43], v[128:131], 0
    s_add_u32 m0, s77, 17408
    s_add_u32 s84, s84, 28672
    buffer_load_dwordx4 v24, s[16:19], s84 offen lds
    v_add_u32 v38, 32768, v38
    v_add_u32 v39, 32768, v39
    ds_read_b64_tr_b16 v[40:41], v38 offset:0
    ds_read_b64_tr_b16 v[42:43], v38 offset:512
    s_waitcnt lgkmcnt(6)
    v_mfma_f32_32x32x16_bf16 v[96:111], v[44:47], v[132:135], v[96:111]
    ds_read_b64_tr_b16 v[44:45], v38 offset:2048
    ds_read_b64_tr_b16 v[46:47], v38 offset:2560
    s_waitcnt lgkmcnt(6)
    v_mfma_f32_32x32x16_bf16 v[96:111], v[48:51], v[136:139], v[96:111]
    ds_read_b64_tr_b16 v[48:49], v38 offset:4096
    ds_read_b64_tr_b16 v[50:51], v38 offset:4608
    s_waitcnt lgkmcnt(6)
    v_mfma_f32_32x32x16_bf16 v[96:111], v[52:55], v[140:143], v[96:111]
    ds_read_b64_tr_b16 v[52:53], v38 offset:6144
    ds_read_b64_tr_b16 v[54:55], v38 offset:6656
    s_waitcnt lgkmcnt(6)
    v_mfma_f32_32x32x16_bf16 v[96:111], v[40:43], v[144:147], v[96:111]
    ds_read_b64_tr_b16 v[40:41], v38 offset:16384
    ds_read_b64_tr_b16 v[42:43], v38 offset:16896
    s_waitcnt lgkmcnt(6)
    v_mfma_f32_32x32x16_bf16 v[96:111], v[44:47], v[148:151], v[96:111]
    ds_read_b64_tr_b16 v[44:45], v38 offset:18432
    ds_read_b64_tr_b16 v[46:47], v38 offset:18944
    s_waitcnt lgkmcnt(6)
    v_mfma_f32_32x32x16_bf16 v[96:111], v[48:51], v[152:155], v[96:111]
    ds_read_b64_tr_b16 v[48:49], v38 offset:20480
    ds_read_b64_tr_b16 v[50:51], v38 offset:20992
    s_waitcnt lgkmcnt(6)
    v_mfma_f32_32x32x16_bf16 v[96:111], v[52:55], v[156:159], v[96:111]
    ds_read_b64_tr_b16 v[52:53], v38 offset:22528
    ds_read_b64_tr_b16 v[54:55], v38 offset:23040
    s_waitcnt lgkmcnt(6)
    v_mfma_f32_32x32x16_bf16 v[96:111], v[40:43], v[160:163], v[96:111]
    v_add_u32 v38, 32768, v38
    v_add_u32 v39, 32768, v39
    ds_read_b64_tr_b16 v[40:41], v38 offset:0
    ds_read_b64_tr_b16 v[42:43], v38 offset:512
    s_waitcnt lgkmcnt(6)
    v_mfma_f32_32x32x16_bf16 v[96:111], v[44:47], v[164:167], v[96:111]
    ds_read_b64_tr_b16 v[44:45], v38 offset:2048
    ds_read_b64_tr_b16 v[46:47], v38 offset:2560
    s_waitcnt lgkmcnt(6)
    v_mfma_f32_32x32x16_bf16 v[96:111], v[48:51], v[168:171], v[96:111]
    ds_read_b64_tr_b16 v[48:49], v38 offset:4096
    ds_read_b64_tr_b16 v[50:51], v38 offset:4608
    s_waitcnt lgkmcnt(6)
    v_mfma_f32_32x32x16_bf16 v[96:111], v[52:55], v[172:175], v[96:111]
    ds_read_b64_tr_b16 v[52:53], v38 offset:6144
    ds_read_b64_tr_b16 v[54:55], v38 offset:6656
    s_waitcnt lgkmcnt(6)
    v_mfma_f32_32x32x16_bf16 v[96:111], v[40:43], v[176:179], v[96:111]
    ds_read_b64_tr_b16 v[40:41], v38 offset:16384
    ds_read_b64_tr_b16 v[42:43], v38 offset:16896
    s_waitcnt lgkmcnt(6)
    v_mfma_f32_32x32x16_bf16 v[96:111], v[44:47], v[180:183], v[96:111]
    ds_read_b64_tr_b16 v[44:45], v38 offset:18432
    ds_read_b64_tr_b16 v[46:47], v38 offset:18944
    s_waitcnt lgkmcnt(6)
    v_mfma_f32_32x32x16_bf16 v[96:111], v[48:51], v[184:187], v[96:111]
    ds_read_b64_tr_b16 v[48:49], v38 offset:20480
    ds_read_b64_tr_b16 v[50:51], v38 offset:20992
    s_waitcnt lgkmcnt(6)
    v_mfma_f32_32x32x16_bf16 v[96:111], v[52:55], v[188:191], v[96:111]
    ds_read_b64_tr_b16 v[52:53], v38 offset:22528
    ds_read_b64_tr_b16 v[54:55], v38 offset:23040
    s_waitcnt lgkmcnt(6)
    v_mfma_f32_32x32x16_bf16 v[96:111], v[40:43], v[192:195], v[96:111]
    s_waitcnt vmcnt(4)
    s_waitcnt lgkmcnt(0)
    s_barrier
    v_add_u32 v38, 32768, v38
    v_add_u32 v39, 32768, v39
    ds_read_b64_tr_b16 v[40:41], v38 offset:0
    ds_read_b64_tr_b16 v[42:43], v38 offset:512
    v_mfma_f32_32x32x16_bf16 v[96:111], v[44:47], v[196:199], v[96:111]
    ds_read_b64_tr_b16 v[44:45], v38 offset:2048
    ds_read_b64_tr_b16 v[46:47], v38 offset:2560
    v_mfma_f32_32x32x16_bf16 v[96:111], v[48:51], v[200:203], v[96:111]
    ds_read_b64_tr_b16 v[48:49], v38 offset:4096
    ds_read_b64_tr_b16 v[50:51], v38 offset:4608
    v_mfma_f32_32x32x16_bf16 v[96:111], v[52:55], v[204:207], v[96:111]
    ds_read_b64_tr_b16 v[52:53], v38 offset:6144
    ds_read_b64_tr_b16 v[54:55], v38 offset:6656
    s_waitcnt lgkmcnt(6)
    v_mfma_f32_32x32x16_bf16 v[96:111], v[40:43], v[208:211], v[96:111]
    s_waitcnt vmcnt(0)
    s_waitcnt lgkmcnt(0)
    s_barrier
    v_subrev_u32 v38, 131072, v38
    v_subrev_u32 v39, 131072, v39
    ds_read_b64_tr_b16 v[40:41], v38 offset:0
    ds_read_b64_tr_b16 v[42:43], v38 offset:512
    v_mfma_f32_32x32x16_bf16 v[96:111], v[44:47], v[212:215], v[96:111]
    ds_read_b64_tr_b16 v[44:45], v38 offset:2048
    ds_read_b64_tr_b16 v[46:47], v38 offset:2560
    v_mfma_f32_32x32x16_bf16 v[96:111], v[48:51], v[216:219], v[96:111]
    ds_read_b64_tr_b16 v[48:49], v38 offset:4096
    ds_read_b64_tr_b16 v[50:51], v38 offset:4608
    v_mfma_f32_32x32x16_bf16 v[96:111], v[52:55], v[220:223], v[96:111]
    ds_read_b64_tr_b16 v[52:53], v38 offset:6144
    ds_read_b64_tr_b16 v[54:55], v38 offset:6656
    s_waitcnt lgkmcnt(6)
    v_mfma_f32_32x32x16_bf16 v[96:111], v[40:43], v[224:227], v[96:111]
    ds_read_b64_tr_b16 v[40:41], v38 offset:16384
    ds_read_b64_tr_b16 v[42:43], v38 offset:16896
    s_waitcnt lgkmcnt(6)
    v_mfma_f32_32x32x16_bf16 v[96:111], v[44:47], v[228:231], v[96:111]
    ds_read_b64_tr_b16 v[44:45], v38 offset:18432
    ds_read_b64_tr_b16 v[46:47], v38 offset:18944
    s_waitcnt lgkmcnt(6)
    v_mfma_f32_32x32x16_bf16 v[96:111], v[48:51], v[232:235], v[96:111]
    ds_read_b64_tr_b16 v[48:49], v38 offset:20480
    ds_read_b64_tr_b16 v[50:51], v38 offset:20992
    s_waitcnt lgkmcnt(6)
    v_mfma_f32_32x32x16_bf16 v[96:111], v[52:55], v[236:239], v[96:111]
    ds_read_b64_tr_b16 v[52:53], v38 offset:22528
    ds_read_b64_tr_b16 v[54:55], v38 offset:23040
    s_waitcnt lgkmcnt(6)
    v_mfma_f32_32x32x16_bf16 v[96:111], v[40:43], v[240:243], v[96:111]
    v_add_u32 v38, 32768, v38
    v_add_u32 v39, 32768, v39
    ds_read_b64_tr_b16 v[40:41], v39 offset:0
    ds_read_b64_tr_b16 v[42:43], v39 offset:512
    s_waitcnt lgkmcnt(6)
    v_mfma_f32_32x32x16_bf16 v[96:111], v[44:47], v[244:247], v[96:111]
    ds_read_b64_tr_b16 v[44:45], v39 offset:2048
    ds_read_b64_tr_b16 v[46:47], v39 offset:2560
    s_waitcnt lgkmcnt(6)
    v_mfma_f32_32x32x16_bf16 v[96:111], v[48:51], v[248:251], v[96:111]
    ds_read_b64_tr_b16 v[48:49], v39 offset:4096
    ds_read_b64_tr_b16 v[50:51], v39 offset:4608
    s_waitcnt lgkmcnt(6)
    v_mfma_f32_32x32x16_bf16 v[96:111], v[52:55], v[252:255], v[96:111]
    v_lshlrev_b32 v13, 3, v0
    v_add_u32 v13, 158272, v13
    ds_read_b64 v[12:13], v13 offset:1024
    s_waitcnt lgkmcnt(0)
    v_mfma_f32_32x32x16_bf16 v[96:111], v[12:15], v[28:31], v[96:111]
    s_nop 7
    s_nop 3
    v_mul_f32 v6, v96, v20
    ds_read_b64_tr_b16 v[52:53], v39 offset:6144
    ds_read_b64_tr_b16 v[54:55], v39 offset:6656
    v_mfma_f32_32x32x16_bf16 v[112:127], v[40:43], v[128:131], 0
    v_mul_f32 v7, v97, v20
    v_exp_f32 v6, v6
    v_exp_f32 v7, v7
    v_mul_f32 v8, v96, v104
    v_mul_f32 v9, v97, v105
    v_fma_f32 v6, v6, v21, v21
    v_fma_f32 v7, v7, v21, v21
    v_rcp_f32 v6, v6
    v_add_u32 v38, 32768, v38
    v_add_u32 v39, 32768, v39
    ds_read_b64_tr_b16 v[40:41], v39 offset:0
    ds_read_b64_tr_b16 v[42:43], v39 offset:512
    v_mfma_f32_32x32x16_bf16 v[112:127], v[44:47], v[132:135], v[112:127]
    v_rcp_f32 v7, v7
    s_nop 0
    v_mul_f32 v8, v8, v6
    v_mul_f32 v9, v9, v7
    v_cvt_pk_bf16_f32 v2, v8, v9
    v_mul_f32 v6, v98, v20
    v_mul_f32 v7, v99, v20
    v_exp_f32 v6, v6
    ds_read_b64_tr_b16 v[44:45], v39 offset:2048
    ds_read_b64_tr_b16 v[46:47], v39 offset:2560
    v_mfma_f32_32x32x16_bf16 v[112:127], v[48:51], v[136:139], v[112:127]
    v_exp_f32 v7, v7
    v_mul_f32 v8, v98, v106
    v_mul_f32 v9, v99, v107
    v_fma_f32 v6, v6, v21, v21
    v_fma_f32 v7, v7, v21, v21
    v_rcp_f32 v6, v6
    v_rcp_f32 v7, v7
    s_nop 0
    ds_read_b64_tr_b16 v[48:49], v39 offset:4096
    ds_read_b64_tr_b16 v[50:51], v39 offset:4608
    s_waitcnt lgkmcnt(6)
    v_mfma_f32_32x32x16_bf16 v[112:127], v[52:55], v[140:143], v[112:127]
    v_mul_f32 v8, v8, v6
    v_mul_f32 v9, v9, v7
    v_cvt_pk_bf16_f32 v3, v8, v9
    v_mul_f32 v6, v100, v20
    v_mul_f32 v7, v101, v20
    v_exp_f32 v6, v6
    v_exp_f32 v7, v7
    v_mul_f32 v8, v100, v108
    ds_read_b64_tr_b16 v[52:53], v39 offset:6144
    ds_read_b64_tr_b16 v[54:55], v39 offset:6656
    s_waitcnt lgkmcnt(6)
    v_mfma_f32_32x32x16_bf16 v[112:127], v[40:43], v[144:147], v[112:127]
    v_mul_f32 v9, v101, v109
    v_fma_f32 v6, v6, v21, v21
    v_fma_f32 v7, v7, v21, v21
    v_rcp_f32 v6, v6
    v_rcp_f32 v7, v7
    s_nop 0
    v_mul_f32 v8, v8, v6
    v_mul_f32 v9, v9, v7
    ds_read_b64_tr_b16 v[40:41], v39 offset:16384
    ds_read_b64_tr_b16 v[42:43], v39 offset:16896
    s_waitcnt lgkmcnt(6)
    v_mfma_f32_32x32x16_bf16 v[112:127], v[44:47], v[148:151], v[112:127]
    v_cvt_pk_bf16_f32 v4, v8, v9
    v_mul_f32 v6, v102, v20
    v_mul_f32 v7, v103, v20
    v_exp_f32 v6, v6
    v_exp_f32 v7, v7
    v_mul_f32 v8, v102, v110
    v_mul_f32 v9, v103, v111
    v_fma_f32 v6, v6, v21, v21
    ds_read_b64_tr_b16 v[44:45], v39 offset:18432
    ds_read_b64_tr_b16 v[46:47], v39 offset:18944
    s_waitcnt lgkmcnt(6)
    v_mfma_f32_32x32x16_bf16 v[112:127], v[48:51], v[152:155], v[112:127]
    v_fma_f32 v7, v7, v21, v21
    v_rcp_f32 v6, v6
    v_rcp_f32 v7, v7
    s_lshl_b32 s90, s81, 5
    v_mul_f32 v8, v8, v6
    v_mul_f32 v9, v9, v7
    v_cvt_pk_bf16_f32 v5, v8, v9
    s_add_u32 s90, s90, s68
    ds_read_b64_tr_b16 v[48:49], v39 offset:20480
    ds_read_b64_tr_b16 v[50:51], v39 offset:20992
    s_waitcnt lgkmcnt(6)
    v_mfma_f32_32x32x16_bf16 v[112:127], v[52:55], v[156:159], v[112:127]
    s_add_u32 s90, s90, 65536
    buffer_store_dwordx4 v[2:5], v27, s[20:23], s90 offen sc0 sc1
    s_nop 0
    ds_read_b64_tr_b16 v[52:53], v39 offset:22528
    ds_read_b64_tr_b16 v[54:55], v39 offset:23040
    s_waitcnt lgkmcnt(6)
    v_mfma_f32_32x32x16_bf16 v[112:127], v[40:43], v[160:163], v[112:127]
    v_add_u32 v38, 32768, v38
    v_add_u32 v39, 32768, v39
    ds_read_b64_tr_b16 v[40:41], v39 offset:0
    ds_read_b64_tr_b16 v[42:43], v39 offset:512
    s_waitcnt lgkmcnt(6)
    v_mfma_f32_32x32x16_bf16 v[112:127], v[44:47], v[164:167], v[112:127]
    ds_read_b64_tr_b16 v[44:45], v39 offset:2048
    ds_read_b64_tr_b16 v[46:47], v39 offset:2560
    s_waitcnt lgkmcnt(6)
    v_mfma_f32_32x32x16_bf16 v[112:127], v[48:51], v[168:171], v[112:127]
    ds_read_b64_tr_b16 v[48:49], v39 offset:4096
    ds_read_b64_tr_b16 v[50:51], v39 offset:4608
    s_waitcnt lgkmcnt(6)
    v_mfma_f32_32x32x16_bf16 v[112:127], v[52:55], v[172:175], v[112:127]
    ds_read_b64_tr_b16 v[52:53], v39 offset:6144
    ds_read_b64_tr_b16 v[54:55], v39 offset:6656
    s_waitcnt lgkmcnt(6)
    v_mfma_f32_32x32x16_bf16 v[112:127], v[40:43], v[176:179], v[112:127]
    ds_read_b64_tr_b16 v[40:41], v39 offset:16384
    ds_read_b64_tr_b16 v[42:43], v39 offset:16896
    s_waitcnt lgkmcnt(6)
    v_mfma_f32_32x32x16_bf16 v[112:127], v[44:47], v[180:183], v[112:127]
    ds_read_b64_tr_b16 v[44:45], v39 offset:18432
    ds_read_b64_tr_b16 v[46:47], v39 offset:18944
    s_waitcnt lgkmcnt(6)
    v_mfma_f32_32x32x16_bf16 v[112:127], v[48:51], v[184:187], v[112:127]
    ds_read_b64_tr_b16 v[48:49], v39 offset:20480
    ds_read_b64_tr_b16 v[50:51], v39 offset:20992
    s_waitcnt lgkmcnt(6)
    v_mfma_f32_32x32x16_bf16 v[112:127], v[52:55], v[188:191], v[112:127]
    ds_read_b64_tr_b16 v[52:53], v39 offset:22528
    ds_read_b64_tr_b16 v[54:55], v39 offset:23040
    s_waitcnt lgkmcnt(6)
    v_mfma_f32_32x32x16_bf16 v[112:127], v[40:43], v[192:195], v[112:127]
    v_add_u32 v38, 32768, v38
    v_add_u32 v39, 32768, v39
    ds_read_b64_tr_b16 v[40:41], v39 offset:0
    ds_read_b64_tr_b16 v[42:43], v39 offset:512
    s_waitcnt lgkmcnt(6)
    v_mfma_f32_32x32x16_bf16 v[112:127], v[44:47], v[196:199], v[112:127]
    ds_read_b64_tr_b16 v[44:45], v39 offset:2048
    ds_read_b64_tr_b16 v[46:47], v39 offset:2560
    s_waitcnt lgkmcnt(6)
    v_mfma_f32_32x32x16_bf16 v[112:127], v[48:51], v[200:203], v[112:127]
    ds_read_b64_tr_b16 v[48:49], v39 offset:4096
    ds_read_b64_tr_b16 v[50:51], v39 offset:4608
    s_waitcnt lgkmcnt(6)
    v_mfma_f32_32x32x16_bf16 v[112:127], v[52:55], v[204:207], v[112:127]
    ds_read_b64_tr_b16 v[52:53], v39 offset:6144
    ds_read_b64_tr_b16 v[54:55], v39 offset:6656
    s_waitcnt lgkmcnt(6)
    v_mfma_f32_32x32x16_bf16 v[112:127], v[40:43], v[208:211], v[112:127]
    v_subrev_u32 v38, 131072, v38
    v_subrev_u32 v39, 131072, v39
    ds_read_b64_tr_b16 v[40:41], v39 offset:0
    ds_read_b64_tr_b16 v[42:43], v39 offset:512
    s_waitcnt lgkmcnt(6)
    v_mfma_f32_32x32x16_bf16 v[112:127], v[44:47], v[212:215], v[112:127]
    ds_read_b64_tr_b16 v[44:45], v39 offset:2048
    ds_read_b64_tr_b16 v[46:47], v39 offset:2560
    s_waitcnt lgkmcnt(6)
    v_mfma_f32_32x32x16_bf16 v[112:127], v[48:51], v[216:219], v[112:127]
    ds_read_b64_tr_b16 v[48:49], v39 offset:4096
    ds_read_b64_tr_b16 v[50:51], v39 offset:4608
    s_waitcnt lgkmcnt(6)
    v_mfma_f32_32x32x16_bf16 v[112:127], v[52:55], v[220:223], v[112:127]
    ds_read_b64_tr_b16 v[52:53], v39 offset:6144
    ds_read_b64_tr_b16 v[54:55], v39 offset:6656
    s_waitcnt lgkmcnt(6)
    v_mfma_f32_32x32x16_bf16 v[112:127], v[40:43], v[224:227], v[112:127]
    s_lshl_b32 s90, s7, 13
    s_add_u32 s90, s90, 409600
    s_add_u32 s91, s90, 4096
    v_and_b32 v2, 31, v0
    v_lshlrev_b32 v2, 4, v2
    buffer_load_dwordx4 v[160:163], v2, s[24:27], s90 offen offset:0 sc1
    buffer_load_dwordx4 v[164:167], v2, s[24:27], s90 offen offset:512 sc1
    buffer_load_dwordx4 v[168:171], v2, s[24:27], s90 offen offset:1024 sc1
    buffer_load_dwordx4 v[172:175], v2, s[24:27], s90 offen offset:1536 sc1
    buffer_load_dwordx4 v[176:179], v2, s[24:27], s90 offen offset:2048 sc1
    buffer_load_dwordx4 v[180:183], v2, s[24:27], s90 offen offset:2560 sc1
    buffer_load_dwordx4 v[184:187], v2, s[24:27], s90 offen offset:3072 sc1
    buffer_load_dwordx4 v[188:191], v2, s[24:27], s90 offen offset:3584 sc1
    buffer_load_dwordx4 v[192:195], v2, s[24:27], s91 offen offset:0 sc1
    buffer_load_dwordx4 v[196:199], v2, s[24:27], s91 offen offset:512 sc1
    buffer_load_dwordx4 v[200:203], v2, s[24:27], s91 offen offset:1024 sc1
    buffer_load_dwordx4 v[204:207], v2, s[24:27], s91 offen offset:1536 sc1
    buffer_load_dwordx4 v[208:211], v2, s[24:27], s91 offen offset:2048 sc1
    buffer_load_dwordx4 v[212:215], v2, s[24:27], s91 offen offset:2560 sc1
    buffer_load_dwordx4 v[216:219], v2, s[24:27], s91 offen offset:3072 sc1
    buffer_load_dwordx4 v[220:223], v2, s[24:27], s91 offen offset:3584 sc1
    ds_read_b64_tr_b16 v[40:41], v39 offset:16384
    ds_read_b64_tr_b16 v[42:43], v39 offset:16896
    s_waitcnt lgkmcnt(6)
    v_mfma_f32_32x32x16_bf16 v[112:127], v[44:47], v[228:231], v[112:127]
    ds_read_b64_tr_b16 v[44:45], v39 offset:18432
    ds_read_b64_tr_b16 v[46:47], v39 offset:18944
    s_waitcnt lgkmcnt(6)
    v_mfma_f32_32x32x16_bf16 v[112:127], v[48:51], v[232:235], v[112:127]
    ds_read_b64_tr_b16 v[48:49], v39 offset:20480
    ds_read_b64_tr_b16 v[50:51], v39 offset:20992
    s_waitcnt lgkmcnt(6)
    v_mfma_f32_32x32x16_bf16 v[112:127], v[52:55], v[236:239], v[112:127]
    ds_read_b64_tr_b16 v[52:53], v39 offset:22528
    ds_read_b64_tr_b16 v[54:55], v39 offset:23040
    s_waitcnt lgkmcnt(6)
    v_mfma_f32_32x32x16_bf16 v[112:127], v[40:43], v[240:243], v[112:127]
    s_waitcnt lgkmcnt(4)
    v_mfma_f32_32x32x16_bf16 v[112:127], v[44:47], v[244:247], v[112:127]
    s_waitcnt lgkmcnt(2)
    v_mfma_f32_32x32x16_bf16 v[112:127], v[48:51], v[248:251], v[112:127]
    s_waitcnt lgkmcnt(0)
    v_mfma_f32_32x32x16_bf16 v[112:127], v[52:55], v[252:255], v[112:127]
    v_lshlrev_b32 v13, 3, v0
    v_add_u32 v13, 158272, v13
    ds_read_b64 v[12:13], v13 offset:1536
    s_waitcnt lgkmcnt(0)
    v_mfma_f32_32x32x16_bf16 v[112:127], v[12:15], v[28:31], v[112:127]
    s_nop 7
    s_nop 3
    v_mul_f32 v6, v112, v20
    v_mul_f32 v7, v113, v20
    v_exp_f32 v6, v6
    v_exp_f32 v7, v7
    v_mul_f32 v8, v112, v120
    v_mul_f32 v9, v113, v121
    v_fma_f32 v6, v6, v21, v21
    v_fma_f32 v7, v7, v21, v21
    v_rcp_f32 v6, v6
    v_rcp_f32 v7, v7
    s_nop 0
    v_mul_f32 v8, v8, v6
    v_mul_f32 v9, v9, v7
    v_cvt_pk_bf16_f32 v2, v8, v9
    v_mul_f32 v6, v114, v20
    v_mul_f32 v7, v115, v20
    v_exp_f32 v6, v6
    v_exp_f32 v7, v7
    v_mul_f32 v8, v114, v122
    v_mul_f32 v9, v115, v123
    v_fma_f32 v6, v6, v21, v21
    v_fma_f32 v7, v7, v21, v21
    v_rcp_f32 v6, v6
    v_rcp_f32 v7, v7
    s_nop 0
    v_mul_f32 v8, v8, v6
    v_mul_f32 v9, v9, v7
    v_cvt_pk_bf16_f32 v3, v8, v9
    v_mul_f32 v6, v116, v20
    v_mul_f32 v7, v117, v20
    v_exp_f32 v6, v6
    v_exp_f32 v7, v7
    v_mul_f32 v8, v116, v124
    v_mul_f32 v9, v117, v125
    v_fma_f32 v6, v6, v21, v21
    v_fma_f32 v7, v7, v21, v21
    v_rcp_f32 v6, v6
    v_rcp_f32 v7, v7
    s_nop 0
    v_mul_f32 v8, v8, v6
    v_mul_f32 v9, v9, v7
    v_cvt_pk_bf16_f32 v4, v8, v9
    v_mul_f32 v6, v118, v20
    v_mul_f32 v7, v119, v20
    v_exp_f32 v6, v6
    v_exp_f32 v7, v7
    v_mul_f32 v8, v118, v126
    v_mul_f32 v9, v119, v127
    v_fma_f32 v6, v6, v21, v21
    v_fma_f32 v7, v7, v21, v21
    v_rcp_f32 v6, v6
    v_rcp_f32 v7, v7
    s_lshl_b32 s90, s81, 5
    v_mul_f32 v8, v8, v6
    v_mul_f32 v9, v9, v7
    v_cvt_pk_bf16_f32 v5, v8, v9
    s_add_u32 s90, s90, s68
    s_add_u32 s90, s90, 66560
    buffer_store_dwordx4 v[2:5], v27, s[20:23], s90 offen sc0 sc1
    s_nop 0
    s_waitcnt vmcnt(1)
    v_mov_b32 v3, 0
    s_cmp_le_u32 s6, 0
    s_cbranch_scc1 K1C0_TCDF
    v_xor_b32 v4, s70, v161
    v_xor_b32 v5, s70, v163
    v_or3_b32 v3, v3, v4, v5
    s_cmp_le_u32 s6, 1
    s_cbranch_scc1 K1C0_TCDF
    v_xor_b32 v4, s70, v165
    v_xor_b32 v5, s70, v167
    v_or3_b32 v3, v3, v4, v5
    s_cmp_le_u32 s6, 2
    s_cbranch_scc1 K1C0_TCDF
    v_xor_b32 v4, s70, v169
    v_xor_b32 v5, s70, v171
    v_or3_b32 v3, v3, v4, v5
    s_cmp_le_u32 s6, 3
    s_cbranch_scc1 K1C0_TCDF
    v_xor_b32 v4, s70, v173
    v_xor_b32 v5, s70, v175
    v_or3_b32 v3, v3, v4, v5
    s_cmp_le_u32 s6, 4
    s_cbranch_scc1 K1C0_TCDF
    v_xor_b32 v4, s70, v177
    v_xor_b32 v5, s70, v179
    v_or3_b32 v3, v3, v4, v5
    s_cmp_le_u32 s6, 5
    s_cbranch_scc1 K1C0_TCDF
    v_xor_b32 v4, s70, v181
    v_xor_b32 v5, s70, v183
    v_or3_b32 v3, v3, v4, v5
    s_cmp_le_u32 s6, 6
    s_cbranch_scc1 K1C0_TCDF
    v_xor_b32 v4, s70, v185
    v_xor_b32 v5, s70, v187
    v_or3_b32 v3, v3, v4, v5
    s_cmp_le_u32 s6, 7
    s_cbranch_scc1 K1C0_TCDF
    v_xor_b32 v4, s70, v189
    v_xor_b32 v5, s70, v191
    v_or3_b32 v3, v3, v4, v5
    s_cmp_le_u32 s6, 8
    s_cbranch_scc1 K1C0_TCDF
    v_xor_b32 v4, s70, v193
    v_xor_b32 v5, s70, v195
    v_or3_b32 v3, v3, v4, v5
    s_cmp_le_u32 s6, 9
    s_cbranch_scc1 K1C0_TCDF
    v_xor_b32 v4, s70, v197
    v_xor_b32 v5, s70, v199
    v_or3_b32 v3, v3, v4, v5
    s_cmp_le_u32 s6, 10
    s_cbranch_scc1 K1C0_TCDF
    v_xor_b32 v4, s70, v201
    v_xor_b32 v5, s70, v203
    v_or3_b32 v3, v3, v4, v5
    s_cmp_le_u32 s6, 11
    s_cbranch_scc1 K1C0_TCDF
    v_xor_b32 v4, s70, v205
    v_xor_b32 v5, s70, v207
    v_or3_b32 v3, v3, v4, v5
    s_cmp_le_u32 s6, 12
    s_cbranch_scc1 K1C0_TCDF
    v_xor_b32 v4, s70, v209
    v_xor_b32 v5, s70, v211
    v_or3_b32 v3, v3, v4, v5
    s_cmp_le_u32 s6, 13
    s_cbranch_scc1 K1C0_TCDF
    v_xor_b32 v4, s70, v213
    v_xor_b32 v5, s70, v215
    v_or3_b32 v3, v3, v4, v5
    s_cmp_le_u32 s6, 14
    s_cbranch_scc1 K1C0_TCDF
    v_xor_b32 v4, s70, v217
    v_xor_b32 v5, s70, v219
    v_or3_b32 v3, v3, v4, v5
K1C0_TCDF:
    v_cmp_ne_u32 vcc, 0, v3
    s_cbranch_vccnz K1C0_E_SLOW
K1C0_E_OK:
    v_mov_b32 v152, 0
    v_mov_b32 v153, 0
    s_cmp_le_u32 s6, 0
    s_cbranch_scc1 K1C0_HD
    v_fma_f32 v2, v60, v152, v160
    v_fma_f32 v3, v60, v153, v162
    v_fma_f32 v2, -v61, v153, v2
    v_fma_f32 v153, v61, v152, v3
    v_mov_b32 v152, v2
    s_cmp_le_u32 s6, 1
    s_cbranch_scc1 K1C0_HD
    v_fma_f32 v2, v60, v152, v164
    v_fma_f32 v3, v60, v153, v166
    v_fma_f32 v2, -v61, v153, v2
    v_fma_f32 v153, v61, v152, v3
    v_mov_b32 v152, v2
    s_cmp_le_u32 s6, 2
    s_cbranch_scc1 K1C0_HD
    v_fma_f32 v2, v60, v152, v168
    v_fma_f32 v3, v60, v153, v170
    v_fma_f32 v2, -v61, v153, v2
    v_fma_f32 v153, v61, v152, v3
    v_mov_b32 v152, v2
    s_cmp_le_u32 s6, 3
    s_cbranch_scc1 K1C0_HD
    v_fma_f32 v2, v60, v152, v172
    v_fma_f32 v3, v60, v153, v174
    v_fma_f32 v2, -v61, v153, v2
    v_fma_f32 v153, v61, v152, v3
    v_mov_b32 v152, v2
    s_cmp_le_u32 s6, 4
    s_cbranch_scc1 K1C0_HD
    v_fma_f32 v2, v60, v152, v176
    v_fma_f32 v3, v60, v153, v178
    v_fma_f32 v2, -v61, v153, v2
    v_fma_f32 v153, v61, v152, v3
    v_mov_b32 v152, v2
    s_cmp_le_u32 s6, 5
    s_cbranch_scc1 K1C0_HD
    v_fma_f32 v2, v60, v152, v180
    v_fma_f32 v3, v60, v153, v182
    v_fma_f32 v2, -v61, v153, v2
    v_fma_f32 v153, v61, v152, v3
    v_mov_b32 v152, v2
    s_cmp_le_u32 s6, 6
    s_cbranch_scc1 K1C0_HD
    v_fma_f32 v2, v60, v152, v184
    v_fma_f32 v3, v60, v153, v186
    v_fma_f32 v2, -v61, v153, v2
    v_fma_f32 v153, v61, v152, v3
    v_mov_b32 v152, v2
    s_cmp_le_u32 s6, 7
    s_cbranch_scc1 K1C0_HD
    v_fma_f32 v2, v60, v152, v188
    v_fma_f32 v3, v60, v153, v190
    v_fma_f32 v2, -v61, v153, v2
    v_fma_f32 v153, v61, v152, v3
    v_mov_b32 v152, v2
    s_cmp_le_u32 s6, 8
    s_cbranch_scc1 K1C0_HD
    v_fma_f32 v2, v60, v152, v192
    v_fma_f32 v3, v60, v153, v194
    v_fma_f32 v2, -v61, v153, v2
    v_fma_f32 v153, v61, v152, v3
    v_mov_b32 v152, v2
    s_cmp_le_u32 s6, 9
    s_cbranch_scc1 K1C0_HD
    v_fma_f32 v2, v60, v152, v196
    v_fma_f32 v3, v60, v153, v198
    v_fma_f32 v2, -v61, v153, v2
    v_fma_f32 v153, v61, v152, v3
    v_mov_b32 v152, v2
    s_cmp_le_u32 s6, 10
    s_cbranch_scc1 K1C0_HD
    v_fma_f32 v2, v60, v152, v200
    v_fma_f32 v3, v60, v153, v202
    v_fma_f32 v2, -v61, v153, v2
    v_fma_f32 v153, v61, v152, v3
    v_mov_b32 v152, v2
    s_cmp_le_u32 s6, 11
    s_cbranch_scc1 K1C0_HD
    v_fma_f32 v2, v60, v152, v204
    v_fma_f32 v3, v60, v153, v206
    v_fma_f32 v2, -v61, v153, v2
    v_fma_f32 v153, v61, v152, v3
    v_mov_b32 v152, v2
    s_cmp_le_u32 s6, 12
    s_cbranch_scc1 K1C0_HD
    v_fma_f32 v2, v60, v152, v208
    v_fma_f32 v3, v60, v153, v210
    v_fma_f32 v2, -v61, v153, v2
    v_fma_f32 v153, v61, v152, v3
    v_mov_b32 v152, v2
    s_cmp_le_u32 s6, 13
    s_cbranch_scc1 K1C0_HD
    v_fma_f32 v2, v60, v152, v212
    v_fma_f32 v3, v60, v153, v214
    v_fma_f32 v2, -v61, v153, v2
    v_fma_f32 v153, v61, v152, v3
    v_mov_b32 v152, v2
    s_cmp_le_u32 s6, 14
    s_cbranch_scc1 K1C0_HD
    v_fma_f32 v2, v60, v152, v216
    v_fma_f32 v3, v60, v153, v218
    v_fma_f32 v2, -v61, v153, v2
    v_fma_f32 v153, v61, v152, v3
    v_mov_b32 v152, v2
K1C0_HD:
    v_fma_f32 v32, v1, v152, v32
    v_fma_f32 v33, v1, v153, v33
    v_fma_f32 v32, -v18, v153, v32
    v_fma_f32 v33, v18, v152, v33
    s_mul_i32 s90, s4, 4608
    s_add_u32 s90, s90, 49152
    s_cmp_eq_u32 s4, 3
    s_cselect_b32 s90, 147456, s90
    v_lshrrev_b32 v6, 5, v0
    v_mul_u32_u24 v6, 2304, v6
    v_and_b32 v7, 31, v0
    v_lshl_add_u32 v6, v7, 2, v6
    v_add_u32 v6, s90, v6
    v_fma_f32 v2, v56, v32, v64
    v_fma_f32 v3, v56, v33, v80
    v_fma_f32 v2, -v57, v33, v2
    v_fma_f32 v3, v57, v32, v3
    v_mul_f32 v8, v62, v2
    v_mul_f32 v9, v62, v3
    v_fma_f32 v8, -v63, v3, v8
    v_fma_f32 v9, v63, v2, v9
    v_cvt_pk_bf16_f32 v8, v8, -v9
    ds_write_b32 v6, v8 offset:0
    v_fma_f32 v4, v56, v2, v65
    v_fma_f32 v5, v56, v3, v81
    v_fma_f32 v4, -v57, v3, v4
    v_fma_f32 v5, v57, v2, v5
    v_mul_f32 v8, v62, v4
    v_mul_f32 v9, v62, v5
    v_fma_f32 v8, -v63, v5, v8
    v_fma_f32 v9, v63, v4, v9
    v_cvt_pk_bf16_f32 v8, v8, -v9
    ds_write_b32 v6, v8 offset:144
    v_fma_f32 v2, v56, v4, v66
    v_fma_f32 v3, v56, v5, v82
    v_fma_f32 v2, -v57, v5, v2
    v_fma_f32 v3, v57, v4, v3
    v_mul_f32 v8, v62, v2
    v_mul_f32 v9, v62, v3
    v_fma_f32 v8, -v63, v3, v8
    v_fma_f32 v9, v63, v2, v9
    v_cvt_pk_bf16_f32 v8, v8, -v9
    ds_write_b32 v6, v8 offset:288
    v_fma_f32 v4, v56, v2, v67
    v_fma_f32 v5, v56, v3, v83
    v_fma_f32 v4, -v57, v3, v4
    v_fma_f32 v5, v57, v2, v5
    v_mul_f32 v8, v62, v4
    v_mul_f32 v9, v62, v5
    v_fma_f32 v8, -v63, v5, v8
    v_fma_f32 v9, v63, v4, v9
    v_cvt_pk_bf16_f32 v8, v8, -v9
    ds_write_b32 v6, v8 offset:432
    v_fma_f32 v2, v56, v4, v68
    v_fma_f32 v3, v56, v5, v84
    v_fma_f32 v2, -v57, v5, v2
    v_fma_f32 v3, v57, v4, v3
    v_mul_f32 v8, v62, v2
    v_mul_f32 v9, v62, v3
    v_fma_f32 v8, -v63, v3, v8
    v_fma_f32 v9, v63, v2, v9
    v_cvt_pk_bf16_f32 v8, v8, -v9
    ds_write_b32 v6, v8 offset:576
    v_fma_f32 v4, v56, v2, v69
    v_fma_f32 v5, v56, v3, v85
    v_fma_f32 v4, -v57, v3, v4
    v_fma_f32 v5, v57, v2, v5
    v_mul_f32 v8, v62, v4
    v_mul_f32 v9, v62, v5
    v_fma_f32 v8, -v63, v5, v8
    v_fma_f32 v9, v63, v4, v9
    v_cvt_pk_bf16_f32 v8, v8, -v9
    ds_write_b32 v6, v8 offset:720
    v_fma_f32 v2, v56, v4, v70
    v_fma_f32 v3, v56, v5, v86
    v_fma_f32 v2, -v57, v5, v2
    v_fma_f32 v3, v57, v4, v3
    v_mul_f32 v8, v62, v2
    v_mul_f32 v9, v62, v3
    v_fma_f32 v8, -v63, v3, v8
    v_fma_f32 v9, v63, v2, v9
    v_cvt_pk_bf16_f32 v8, v8, -v9
    ds_write_b32 v6, v8 offset:864
    v_fma_f32 v4, v56, v2, v71
    v_fma_f32 v5, v56, v3, v87
    v_fma_f32 v4, -v57, v3, v4
    v_fma_f32 v5, v57, v2, v5
    v_mul_f32 v8, v62, v4
    v_mul_f32 v9, v62, v5
    v_fma_f32 v8, -v63, v5, v8
    v_fma_f32 v9, v63, v4, v9
    v_cvt_pk_bf16_f32 v8, v8, -v9
    ds_write_b32 v6, v8 offset:1008
    v_fma_f32 v2, v56, v4, v72
    v_fma_f32 v3, v56, v5, v88
    v_fma_f32 v2, -v57, v5, v2
    v_fma_f32 v3, v57, v4, v3
    v_mul_f32 v8, v62, v2
    v_mul_f32 v9, v62, v3
    v_fma_f32 v8, -v63, v3, v8
    v_fma_f32 v9, v63, v2, v9
    v_cvt_pk_bf16_f32 v8, v8, -v9
    ds_write_b32 v6, v8 offset:1152
    v_fma_f32 v4, v56, v2, v73
    v_fma_f32 v5, v56, v3, v89
    v_fma_f32 v4, -v57, v3, v4
    v_fma_f32 v5, v57, v2, v5
    v_mul_f32 v8, v62, v4
    v_mul_f32 v9, v62, v5
    v_fma_f32 v8, -v63, v5, v8
    v_fma_f32 v9, v63, v4, v9
    v_cvt_pk_bf16_f32 v8, v8, -v9
    ds_write_b32 v6, v8 offset:1296
    v_fma_f32 v2, v56, v4, v74
    v_fma_f32 v3, v56, v5, v90
    v_fma_f32 v2, -v57, v5, v2
    v_fma_f32 v3, v57, v4, v3
    v_mul_f32 v8, v62, v2
    v_mul_f32 v9, v62, v3
    v_fma_f32 v8, -v63, v3, v8
    v_fma_f32 v9, v63, v2, v9
    v_cvt_pk_bf16_f32 v8, v8, -v9
    ds_write_b32 v6, v8 offset:1440
    v_fma_f32 v4, v56, v2, v75
    v_fma_f32 v5, v56, v3, v91
    v_fma_f32 v4, -v57, v3, v4
    v_fma_f32 v5, v57, v2, v5
    v_mul_f32 v8, v62, v4
    v_mul_f32 v9, v62, v5
    v_fma_f32 v8, -v63, v5, v8
    v_fma_f32 v9, v63, v4, v9
    v_cvt_pk_bf16_f32 v8, v8, -v9
    ds_write_b32 v6, v8 offset:1584
    v_fma_f32 v2, v56, v4, v76
    v_fma_f32 v3, v56, v5, v92
    v_fma_f32 v2, -v57, v5, v2
    v_fma_f32 v3, v57, v4, v3
    v_mul_f32 v8, v62, v2
    v_mul_f32 v9, v62, v3
    v_fma_f32 v8, -v63, v3, v8
    v_fma_f32 v9, v63, v2, v9
    v_cvt_pk_bf16_f32 v8, v8, -v9
    ds_write_b32 v6, v8 offset:1728
    v_fma_f32 v4, v56, v2, v77
    v_fma_f32 v5, v56, v3, v93
    v_fma_f32 v4, -v57, v3, v4
    v_fma_f32 v5, v57, v2, v5
    v_mul_f32 v8, v62, v4
    v_mul_f32 v9, v62, v5
    v_fma_f32 v8, -v63, v5, v8
    v_fma_f32 v9, v63, v4, v9
    v_cvt_pk_bf16_f32 v8, v8, -v9
    ds_write_b32 v6, v8 offset:1872
    v_fma_f32 v2, v56, v4, v78
    v_fma_f32 v3, v56, v5, v94
    v_fma_f32 v2, -v57, v5, v2
    v_fma_f32 v3, v57, v4, v3
    v_mul_f32 v8, v62, v2
    v_mul_f32 v9, v62, v3
    v_fma_f32 v8, -v63, v3, v8
    v_fma_f32 v9, v63, v2, v9
    v_cvt_pk_bf16_f32 v8, v8, -v9
    ds_write_b32 v6, v8 offset:2016
    v_fma_f32 v4, v56, v2, v79
    v_fma_f32 v5, v56, v3, v95
    v_fma_f32 v4, -v57, v3, v4
    v_fma_f32 v5, v57, v2, v5
    v_mul_f32 v8, v62, v4
    v_mul_f32 v9, v62, v5
    v_fma_f32 v8, -v63, v5, v8
    v_fma_f32 v9, v63, v4, v9
    v_cvt_pk_bf16_f32 v8, v8, -v9
    ds_write_b32 v6, v8 offset:2160
    v_mul_u32_u24 v6, 144, v16
    v_lshrrev_b32 v7, 5, v0
    v_lshl_add_u32 v6, v7, 4, v6
    v_add_u32 v6, s90, v6
    s_waitcnt lgkmcnt(0)
    ds_read_b128 v[128:131], v6 offset:0
    ds_read_b128 v[132:135], v6 offset:32
    ds_read_b128 v[136:139], v6 offset:64
    ds_read_b128 v[140:143], v6 offset:96
    s_waitcnt lgkmcnt(0)
    s_lshl_b32 s90, s7, 12
    s_add_u32 s90, s90, s68
    buffer_store_dwordx4 v[128:131], v27, s[20:23], s90 offen offset:0 sc0 sc1
    buffer_store_dwordx4 v[132:135], v27, s[20:23], s90 offen offset:1024 sc0 sc1
    buffer_store_dwordx4 v[136:139], v27, s[20:23], s90 offen offset:2048 sc0 sc1
    buffer_store_dwordx4 v[140:143], v27, s[20:23], s90 offen offset:3072 sc0 sc1
    s_branch K1_FIN
K1_CH1:
    s_lshl_b32 s68, s6, 2
    s_add_u32 s68, s68, s4
    s_mul_i32 s68, s68, 180224
    s_mul_i32 s69, s7, 9
    s_lshl_b32 s69, s69, 10
    s_add_u32 s69, s69, 16384
    s_lshl_b32 s71, s6, 7
    s_lshl_b32 s90, s4, 5
    s_add_u32 s71, s71, s90
    s_lshl_b32 s71, s71, 3
    ds_read_b128 v[128:131], v28 offset:0
    ds_read_b64_tr_b16 v[40:41], v36 offset:24576
    ds_read_b64_tr_b16 v[42:43], v36 offset:24832
    ds_read_b64_tr_b16 v[44:45], v37 offset:24576
    ds_read_b64_tr_b16 v[46:47], v37 offset:24832
    ds_read_b128 v[132:135], v29 offset:0
    ds_read_b64_tr_b16 v[48:49], v36 offset:25600
    ds_read_b64_tr_b16 v[50:51], v36 offset:25856
    ds_read_b64_tr_b16 v[52:53], v37 offset:25600
    ds_read_b64_tr_b16 v[54:55], v37 offset:25856
    ds_read_b128 v[136:139], v30 offset:0
    ds_read_b64_tr_b16 v[56:57], v36 offset:26624
    ds_read_b64_tr_b16 v[58:59], v36 offset:26880
    ds_read_b64_tr_b16 v[60:61], v37 offset:26624
    ds_read_b64_tr_b16 v[62:63], v37 offset:26880
    s_waitcnt lgkmcnt(10)
    v_mfma_f32_32x32x16_bf16 v[64:79], v[40:43], v[128:131], 0
    s_add_u32 m0, s76, 65536
    s_add_u32 s84, s78, s38
    buffer_load_dwordx4 v20, s[8:11], s84 offen lds
    ds_read_b128 v[140:143], v31 offset:0
    ds_read_b64_tr_b16 v[40:41], v36 offset:27648
    ds_read_b64_tr_b16 v[42:43], v36 offset:27904
    v_mfma_f32_32x32x16_bf16 v[80:95], v[44:47], v[128:131], 0
    s_add_u32 m0, s76, 66560
    s_add_u32 s84, s78, s38
    buffer_load_dwordx4 v21, s[8:11], s84 offen lds
    ds_read_b64_tr_b16 v[44:45], v37 offset:27648
    ds_read_b64_tr_b16 v[46:47], v37 offset:27904
    s_waitcnt lgkmcnt(10)
    v_mfma_f32_32x32x16_bf16 v[64:79], v[48:51], v[132:135], v[64:79]
    s_add_u32 m0, s75, 81920
    s_mov_b32 s84, s38
    buffer_load_dwordx4 v22, s[12:15], s84 offen lds
    s_add_u32 m0, s75, 90112
    s_add_u32 s84, s80, s52
    buffer_load_dwordx4 v23, s[16:19], s84 offen lds
    s_add_u32 m0, s76, 98304
    s_add_u32 s84, s78, s39
    buffer_load_dwordx4 v20, s[8:11], s84 offen lds
    s_add_u32 m0, s76, 99328
    s_add_u32 s84, s78, s39
    buffer_load_dwordx4 v21, s[8:11], s84 offen lds
    s_add_u32 m0, s75, 114688
    s_mov_b32 s84, s39
    buffer_load_dwordx4 v22, s[12:15], s84 offen lds
    s_add_u32 m0, s75, 122880
    s_add_u32 s84, s80, s53
    buffer_load_dwordx4 v23, s[16:19], s84 offen lds
    s_cmp_eq_u32 s88, 0
    s_cbranch_scc1 K1_MINI0_C1
    s_mul_i32 s91, s89, 458752
    s_cmp_eq_u32 s88, 1
    s_cbranch_scc1 K1_MINI1_C1
    s_sub_u32 s90, s88, 2
    s_lshl_b32 s90, s90, 6
    s_add_u32 s90, s90, s81
    s_add_u32 s90, s90, s91
    s_add_u32 m0, s75, 131072
    s_add_u32 s84, s90, 0
    buffer_load_dwordx4 v23, s[16:19], s84 offen lds
    s_add_u32 m0, s75, 139264
    s_add_u32 s84, s90, 229376
    buffer_load_dwordx4 v23, s[16:19], s84 offen lds
    s_branch K1_MINIDONE_C1
K1_MINI1_C1:
    s_add_u32 s90, s80, s91
    s_add_u32 m0, s75, 131072
    s_add_u32 s84, s90, 0
    buffer_load_dwordx4 v23, s[16:19], s84 offen lds
    s_add_u32 m0, s75, 139264
    s_add_u32 s84, s90, 229376
    buffer_load_dwordx4 v23, s[16:19], s84 offen lds
    s_add_u32 s90, s79, s91
    v_lshrrev_b32 v2, 1, v0
    s_lshl_b32 s91, s4, 5
    v_add_u32 v2, s91, v2
    s_movk_i32 s91, 3584
    v_mul_lo_u32 v2, v2, s91
    v_and_b32 v3, 1, v0
    v_lshl_add_u32 v2, v3, 4, v2
    s_add_u32 m0, s75, 147456
    s_add_u32 s84, s90, 0
    buffer_load_dwordx4 v2, s[16:19], s84 offen lds
    s_branch K1_MINIDONE_C1
K1_MINI0_C1:
    s_lshl_b32 s90, s89, 8
    s_add_u32 m0, s75, 131072
    s_add_u32 s84, s90, 0
    buffer_load_dwordx4 v22, s[12:15], s84 offen lds
    s_add_u32 m0, s75, 139264
    s_add_u32 s84, s90, 128
    buffer_load_dwordx4 v22, s[12:15], s84 offen lds
K1_MINIDONE_C1:
    s_waitcnt vmcnt(9)
    s_waitcnt lgkmcnt(0)
    s_barrier
    v_add_u32 v28, 32768, v28
    v_add_u32 v29, 32768, v29
    v_add_u32 v30, 32768, v30
    v_add_u32 v31, 32768, v31
    ds_read_b128 v[144:147], v28 offset:0
    v_add_u32 v36, 32768, v36
    v_add_u32 v37, 32768, v37
    ds_read_b64_tr_b16 v[48:49], v36 offset:24576
    ds_read_b64_tr_b16 v[50:51], v36 offset:24832
    v_mfma_f32_32x32x16_bf16 v[80:95], v[52:55], v[132:135], v[80:95]
    s_add_u32 m0, s76, 0
    s_add_u32 s84, s78, s40
    buffer_load_dwordx4 v20, s[8:11], s84 offen lds
    ds_read_b64_tr_b16 v[52:53], v37 offset:24576
    ds_read_b64_tr_b16 v[54:55], v37 offset:24832
    v_mfma_f32_32x32x16_bf16 v[64:79], v[56:59], v[136:139], v[64:79]
    s_add_u32 m0, s76, 1024
    s_add_u32 s84, s78, s40
    buffer_load_dwordx4 v21, s[8:11], s84 offen lds
    ds_read_b128 v[148:151], v29 offset:0
    ds_read_b64_tr_b16 v[56:57], v36 offset:25600
    ds_read_b64_tr_b16 v[58:59], v36 offset:25856
    v_mfma_f32_32x32x16_bf16 v[80:95], v[60:63], v[136:139], v[80:95]
    s_add_u32 m0, s75, 16384
    s_mov_b32 s84, s40
    buffer_load_dwordx4 v22, s[12:15], s84 offen lds
    ds_read_b64_tr_b16 v[60:61], v37 offset:25600
    ds_read_b64_tr_b16 v[62:63], v37 offset:25856
    v_mfma_f32_32x32x16_bf16 v[64:79], v[40:43], v[140:143], v[64:79]
    s_add_u32 m0, s75, 24576
    s_add_u32 s84, s80, s54
    buffer_load_dwordx4 v23, s[16:19], s84 offen lds
    ds_read_b128 v[152:155], v30 offset:0
    ds_read_b64_tr_b16 v[40:41], v36 offset:26624
    ds_read_b64_tr_b16 v[42:43], v36 offset:26880
    v_mfma_f32_32x32x16_bf16 v[80:95], v[44:47], v[140:143], v[80:95]
    ds_read_b64_tr_b16 v[44:45], v37 offset:26624
    ds_read_b64_tr_b16 v[46:47], v37 offset:26880
    s_waitcnt lgkmcnt(10)
    v_mfma_f32_32x32x16_bf16 v[64:79], v[48:51], v[144:147], v[64:79]
    ds_read_b128 v[156:159], v31 offset:0
    ds_read_b64_tr_b16 v[48:49], v36 offset:27648
    ds_read_b64_tr_b16 v[50:51], v36 offset:27904
    v_mfma_f32_32x32x16_bf16 v[80:95], v[52:55], v[144:147], v[80:95]
    ds_read_b64_tr_b16 v[52:53], v37 offset:27648
    ds_read_b64_tr_b16 v[54:55], v37 offset:27904
    s_waitcnt lgkmcnt(10)
    v_mfma_f32_32x32x16_bf16 v[64:79], v[56:59], v[148:151], v[64:79]
    s_waitcnt vmcnt(8)
    s_waitcnt vmcnt(4)
    s_waitcnt lgkmcnt(0)
    s_barrier
    v_add_u32 v28, 32768, v28
    v_add_u32 v29, 32768, v29
    v_add_u32 v30, 32768, v30
    v_add_u32 v31, 32768, v31
    ds_read_b128 v[160:163], v28 offset:0
    v_add_u32 v36, 32768, v36
    v_add_u32 v37, 32768, v37
    ds_read_b64_tr_b16 v[56:57], v36 offset:24576
    ds_read_b64_tr_b16 v[58:59], v36 offset:24832
    v_mfma_f32_32x32x16_bf16 v[80:95], v[60:63], v[148:151], v[80:95]
    s_add_u32 m0, s76, 32768
    s_add_u32 s84, s78, s41
    buffer_load_dwordx4 v20, s[8:11], s84 offen lds
    ds_read_b64_tr_b16 v[60:61], v37 offset:24576
    ds_read_b64_tr_b16 v[62:63], v37 offset:24832
    v_mfma_f32_32x32x16_bf16 v[64:79], v[40:43], v[152:155], v[64:79]
    s_add_u32 m0, s76, 33792
    s_add_u32 s84, s78, s41
    buffer_load_dwordx4 v21, s[8:11], s84 offen lds
    ds_read_b128 v[164:167], v29 offset:0
    ds_read_b64_tr_b16 v[40:41], v36 offset:25600
    ds_read_b64_tr_b16 v[42:43], v36 offset:25856
    v_mfma_f32_32x32x16_bf16 v[80:95], v[44:47], v[152:155], v[80:95]
    s_add_u32 m0, s75, 49152
    s_mov_b32 s84, s41
    buffer_load_dwordx4 v22, s[12:15], s84 offen lds
    ds_read_b64_tr_b16 v[44:45], v37 offset:25600
    ds_read_b64_tr_b16 v[46:47], v37 offset:25856
    v_mfma_f32_32x32x16_bf16 v[64:79], v[48:51], v[156:159], v[64:79]
    s_add_u32 m0, s75, 57344
    s_add_u32 s84, s80, s55
    buffer_load_dwordx4 v23, s[16:19], s84 offen lds
    ds_read_b128 v[168:171], v30 offset:0
    ds_read_b64_tr_b16 v[48:49], v36 offset:26624
    ds_read_b64_tr_b16 v[50:51], v36 offset:26880
    v_mfma_f32_32x32x16_bf16 v[80:95], v[52:55], v[156:159], v[80:95]
    ds_read_b64_tr_b16 v[52:53], v37 offset:26624
    ds_read_b64_tr_b16 v[54:55], v37 offset:26880
    s_waitcnt lgkmcnt(10)
    v_mfma_f32_32x32x16_bf16 v[64:79], v[56:59], v[160:163], v[64:79]
    ds_read_b128 v[172:175], v31 offset:0
    ds_read_b64_tr_b16 v[56:57], v36 offset:27648
    ds_read_b64_tr_b16 v[58:59], v36 offset:27904
    v_mfma_f32_32x32x16_bf16 v[80:95], v[60:63], v[160:163], v[80:95]
    ds_read_b64_tr_b16 v[60:61], v37 offset:27648
    ds_read_b64_tr_b16 v[62:63], v37 offset:27904
    s_waitcnt lgkmcnt(10)
    v_mfma_f32_32x32x16_bf16 v[64:79], v[40:43], v[164:167], v[64:79]
    s_waitcnt lgkmcnt(0)
    s_barrier
    v_add_u32 v28, 32768, v28
    v_add_u32 v29, 32768, v29
    v_add_u32 v30, 32768, v30
    v_add_u32 v31, 32768, v31
    ds_read_b128 v[176:179], v28 offset:0
    v_add_u32 v36, 32768, v36
    v_add_u32 v37, 32768, v37
    ds_read_b64_tr_b16 v[40:41], v36 offset:24576
    ds_read_b64_tr_b16 v[42:43], v36 offset:24832
    v_mfma_f32_32x32x16_bf16 v[80:95], v[44:47], v[164:167], v[80:95]
    s_add_u32 m0, s76, 65536
    s_add_u32 s84, s78, s42
    buffer_load_dwordx4 v20, s[8:11], s84 offen lds
    ds_read_b64_tr_b16 v[44:45], v37 offset:24576
    ds_read_b64_tr_b16 v[46:47], v37 offset:24832
    v_mfma_f32_32x32x16_bf16 v[64:79], v[48:51], v[168:171], v[64:79]
    s_add_u32 m0, s76, 66560
    s_add_u32 s84, s78, s42
    buffer_load_dwordx4 v21, s[8:11], s84 offen lds
    ds_read_b128 v[180:183], v29 offset:0
    ds_read_b64_tr_b16 v[48:49], v36 offset:25600
    ds_read_b64_tr_b16 v[50:51], v36 offset:25856
    v_mfma_f32_32x32x16_bf16 v[80:95], v[52:55], v[168:171], v[80:95]
    s_add_u32 m0, s75, 81920
    s_mov_b32 s84, s42
    buffer_load_dwordx4 v22, s[12:15], s84 offen lds
    ds_read_b64_tr_b16 v[52:53], v37 offset:25600
    ds_read_b64_tr_b16 v[54:55], v37 offset:25856
    v_mfma_f32_32x32x16_bf16 v[64:79], v[56:59], v[172:175], v[64:79]
    s_add_u32 m0, s75, 90112
    s_add_u32 s84, s80, s56
    buffer_load_dwordx4 v23, s[16:19], s84 offen lds
    ds_read_b128 v[184:187], v30 offset:0
    ds_read_b64_tr_b16 v[56:57], v36 offset:26624
    ds_read_b64_tr_b16 v[58:59], v36 offset:26880
    v_mfma_f32_32x32x16_bf16 v[80:95], v[60:63], v[172:175], v[80:95]
    ds_read_b64_tr_b16 v[60:61], v37 offset:26624
    ds_read_b64_tr_b16 v[62:63], v37 offset:26880
    s_waitcnt lgkmcnt(10)
    v_mfma_f32_32x32x16_bf16 v[64:79], v[40:43], v[176:179], v[64:79]
    ds_read_b128 v[188:191], v31 offset:0
    ds_read_b64_tr_b16 v[40:41], v36 offset:27648
    ds_read_b64_tr_b16 v[42:43], v36 offset:27904
    v_mfma_f32_32x32x16_bf16 v[80:95], v[44:47], v[176:179], v[80:95]
    ds_read_b64_tr_b16 v[44:45], v37 offset:27648
    ds_read_b64_tr_b16 v[46:47], v37 offset:27904
    s_waitcnt lgkmcnt(10)
    v_mfma_f32_32x32x16_bf16 v[64:79], v[48:51], v[180:183], v[64:79]
    s_waitcnt vmcnt(8)
    s_waitcnt lgkmcnt(0)
    s_barrier
    v_subrev_u32 v28, 98304, v28
    v_subrev_u32 v29, 98304, v29
    v_subrev_u32 v30, 98304, v30
    v_subrev_u32 v31, 98304, v31
    ds_read_b128 v[192:195], v28 offset:0
    v_subrev_u32 v36, 98304, v36
    v_subrev_u32 v37, 98304, v37
    ds_read_b64_tr_b16 v[48:49], v36 offset:24576
    ds_read_b64_tr_b16 v[50:51], v36 offset:24832
    v_mfma_f32_32x32x16_bf16 v[80:95], v[52:55], v[180:183], v[80:95]
    s_add_u32 m0, s76, 98304
    s_add_u32 s84, s78, s43
    buffer_load_dwordx4 v20, s[8:11], s84 offen lds
    ds_read_b64_tr_b16 v[52:53], v37 offset:24576
    ds_read_b64_tr_b16 v[54:55], v37 offset:24832
    v_mfma_f32_32x32x16_bf16 v[64:79], v[56:59], v[184:187], v[64:79]
    s_add_u32 m0, s76, 99328
    s_add_u32 s84, s78, s43
    buffer_load_dwordx4 v21, s[8:11], s84 offen lds
    ds_read_b128 v[196:199], v29 offset:0
    ds_read_b64_tr_b16 v[56:57], v36 offset:25600
    ds_read_b64_tr_b16 v[58:59], v36 offset:25856
    v_mfma_f32_32x32x16_bf16 v[80:95], v[60:63], v[184:187], v[80:95]
    s_add_u32 m0, s75, 114688
    s_mov_b32 s84, s43
    buffer_load_dwordx4 v22, s[12:15], s84 offen lds
    ds_read_b64_tr_b16 v[60:61], v37 offset:25600
    ds_read_b64_tr_b16 v[62:63], v37 offset:25856
    v_mfma_f32_32x32x16_bf16 v[64:79], v[40:43], v[188:191], v[64:79]
    s_add_u32 m0, s75, 122880
    s_add_u32 s84, s80, s57
    buffer_load_dwordx4 v23, s[16:19], s84 offen lds
    ds_read_b128 v[200:203], v30 offset:0
    ds_read_b64_tr_b16 v[40:41], v36 offset:26624
    ds_read_b64_tr_b16 v[42:43], v36 offset:26880
    v_mfma_f32_32x32x16_bf16 v[80:95], v[44:47], v[188:191], v[80:95]
    ds_read_b64_tr_b16 v[44:45], v37 offset:26624
    ds_read_b64_tr_b16 v[46:47], v37 offset:26880
    s_waitcnt lgkmcnt(10)
    v_mfma_f32_32x32x16_bf16 v[64:79], v[48:51], v[192:195], v[64:79]
    ds_read_b128 v[204:207], v31 offset:0
    ds_read_b64_tr_b16 v[48:49], v36 offset:27648
    ds_read_b64_tr_b16 v[50:51], v36 offset:27904
    v_mfma_f32_32x32x16_bf16 v[80:95], v[52:55], v[192:195], v[80:95]
    ds_read_b64_tr_b16 v[52:53], v37 offset:27648
    ds_read_b64_tr_b16 v[54:55], v37 offset:27904
    s_waitcnt lgkmcnt(10)
    v_mfma_f32_32x32x16_bf16 v[64:79], v[56:59], v[196:199], v[64:79]
    s_waitcnt vmcnt(8)
    s_waitcnt lgkmcnt(0)
    s_barrier
    v_lshlrev_b32 v10, 3, v16
    buffer_load_dwordx2 v[10:11], v10, s[24:27], s71 offen offset:0 sc1
    s_add_u32 s90, s69, 2048
    buffer_load_dwordx4 v[108:111], v27, s[24:27], s90 offen sc1
    s_add_u32 s90, s69, 3072
    buffer_load_dwordx4 v[112:115], v27, s[24:27], s90 offen sc1
    s_add_u32 s90, s69, 6144
    buffer_load_dwordx4 v[116:119], v27, s[24:27], s90 offen sc1
    s_add_u32 s90, s69, 7168
    buffer_load_dwordx4 v[120:123], v27, s[24:27], s90 offen sc1
    s_add_u32 s90, s69, 8192
    buffer_load_dwordx4 v[124:127], v27, s[24:27], s90 offen sc1
    v_add_u32 v28, 32768, v28
    v_add_u32 v29, 32768, v29
    v_add_u32 v30, 32768, v30
    v_add_u32 v31, 32768, v31
    ds_read_b128 v[208:211], v28 offset:0
    v_add_u32 v36, 32768, v36
    v_add_u32 v37, 32768, v37
    ds_read_b64_tr_b16 v[56:57], v36 offset:24576
    ds_read_b64_tr_b16 v[58:59], v36 offset:24832
    v_mfma_f32_32x32x16_bf16 v[80:95], v[60:63], v[196:199], v[80:95]
    s_add_u32 m0, s75, 131072
    s_add_u32 s84, s82, s50
    buffer_load_dwordx4 v23, s[16:19], s84 offen lds
    ds_read_b64_tr_b16 v[60:61], v37 offset:24576
    ds_read_b64_tr_b16 v[62:63], v37 offset:24832
    v_mfma_f32_32x32x16_bf16 v[64:79], v[40:43], v[200:203], v[64:79]
    s_add_u32 m0, s75, 139264
    s_add_u32 s84, s82, s51
    buffer_load_dwordx4 v23, s[16:19], s84 offen lds
    ds_read_b128 v[212:215], v29 offset:0
    ds_read_b64_tr_b16 v[40:41], v36 offset:25600
    ds_read_b64_tr_b16 v[42:43], v36 offset:25856
    v_mfma_f32_32x32x16_bf16 v[80:95], v[44:47], v[200:203], v[80:95]
    s_add_u32 m0, s75, 147456
    s_add_u32 s84, s82, s52
    buffer_load_dwordx4 v23, s[16:19], s84 offen lds
    ds_read_b64_tr_b16 v[44:45], v37 offset:25600
    ds_read_b64_tr_b16 v[46:47], v37 offset:25856
    v_mfma_f32_32x32x16_bf16 v[64:79], v[48:51], v[204:207], v[64:79]
    ds_read_b128 v[216:219], v30 offset:0
    ds_read_b64_tr_b16 v[48:49], v36 offset:26624
    ds_read_b64_tr_b16 v[50:51], v36 offset:26880
    v_mfma_f32_32x32x16_bf16 v[80:95], v[52:55], v[204:207], v[80:95]
    ds_read_b64_tr_b16 v[52:53], v37 offset:26624
    ds_read_b64_tr_b16 v[54:55], v37 offset:26880
    s_waitcnt lgkmcnt(10)
    v_mfma_f32_32x32x16_bf16 v[64:79], v[56:59], v[208:211], v[64:79]
    ds_read_b128 v[220:223], v31 offset:0
    ds_read_b64_tr_b16 v[56:57], v36 offset:27648
    ds_read_b64_tr_b16 v[58:59], v36 offset:27904
    v_mfma_f32_32x32x16_bf16 v[80:95], v[60:63], v[208:211], v[80:95]
    ds_read_b64_tr_b16 v[60:61], v37 offset:27648
    ds_read_b64_tr_b16 v[62:63], v37 offset:27904
    s_waitcnt lgkmcnt(10)
    v_mfma_f32_32x32x16_bf16 v[64:79], v[40:43], v[212:215], v[64:79]
    s_waitcnt vmcnt(13)
    s_waitcnt lgkmcnt(0)
    s_barrier
    v_add_u32 v28, 32768, v28
    v_add_u32 v29, 32768, v29
    v_add_u32 v30, 32768, v30
    v_add_u32 v31, 32768, v31
    ds_read_b128 v[224:227], v28 offset:0
    v_add_u32 v36, 32768, v36
    v_add_u32 v37, 32768, v37
    ds_read_b64_tr_b16 v[40:41], v36 offset:24576
    ds_read_b64_tr_b16 v[42:43], v36 offset:24832
    v_mfma_f32_32x32x16_bf16 v[80:95], v[44:47], v[212:215], v[80:95]
    s_add_u32 m0, s75, 0
    s_add_u32 s84, s82, s53
    buffer_load_dwordx4 v23, s[16:19], s84 offen lds
    s_waitcnt vmcnt(9)
    v_cmp_ne_u32 vcc, s70, v11
    s_cbranch_vccnz K1C1_ST_SLOW
K1C1_ST_OK:
    v_and_b32 v17, 0xffff0000, v10
    v_mul_f32 v21, v17, v17
    v_rcp_f32 v17, v17
    v_and_b32 v11, 0xffff, v10
    ds_read_b64_tr_b16 v[44:45], v37 offset:24576
    ds_read_b64_tr_b16 v[46:47], v37 offset:24832
    v_mfma_f32_32x32x16_bf16 v[64:79], v[48:51], v[216:219], v[64:79]
    s_add_u32 m0, s75, 8192
    s_add_u32 s84, s82, s54
    buffer_load_dwordx4 v23, s[16:19], s84 offen lds
    v_xor_b32 v11, 0x8000, v11
    v_cmp_gt_u32 vcc, 32, v0
    v_lshl_or_b32 v10, v11, 16, v11
    v_mul_f32 v20, 0xbfb8aa3b, v17
    v_cndmask_b32 v10, 0, v10, vcc
    ds_read_b128 v[228:231], v29 offset:0
    ds_read_b64_tr_b16 v[48:49], v36 offset:25600
    ds_read_b64_tr_b16 v[50:51], v36 offset:25856
    v_mfma_f32_32x32x16_bf16 v[80:95], v[52:55], v[216:219], v[80:95]
    s_add_u32 m0, s75, 16384
    s_add_u32 s84, s82, s55
    buffer_load_dwordx4 v23, s[16:19], s84 offen lds
    v_cndmask_b32 v11, 0, v11, vcc
    s_waitcnt vmcnt(10)
    v_cmp_ne_u32 vcc, s70, v109
    v_cmp_ne_u32 s[90:91], s70, v111
    s_or_b64 vcc, vcc, s[90:91]
    s_cbranch_vccnz K1C1_CS2_SLOW
K1C1_CS2_OK:
    s_waitcnt vmcnt(9)
    v_cmp_ne_u32 vcc, s70, v113
    v_cmp_ne_u32 s[90:91], s70, v115
    s_or_b64 vcc, vcc, s[90:91]
    s_cbranch_vccnz K1C1_CS3_SLOW
K1C1_CS3_OK:
    s_waitcnt vmcnt(8)
    v_cmp_ne_u32 vcc, s70, v117
    v_cmp_ne_u32 s[90:91], s70, v119
    s_or_b64 vcc, vcc, s[90:91]
    s_cbranch_vccnz K1C1_CS6_SLOW
K1C1_CS6_OK:
    s_waitcnt vmcnt(7)
    v_cmp_ne_u32 vcc, s70, v121
    v_cmp_ne_u32 s[90:91], s70, v123
    s_or_b64 vcc, vcc, s[90:91]
    s_cbranch_vccnz K1C1_CS7_SLOW
K1C1_CS7_OK:
    ds_read_b64_tr_b16 v[52:53], v37 offset:25600
    ds_read_b64_tr_b16 v[54:55], v37 offset:25856
    v_mfma_f32_32x32x16_bf16 v[64:79], v[56:59], v[220:223], v[64:79]
    s_add_u32 m0, s75, 24576
    s_add_u32 s84, s82, s56
    buffer_load_dwordx4 v23, s[16:19], s84 offen lds
    s_waitcnt vmcnt(7)
    v_cmp_ne_u32 vcc, s70, v125
    v_cmp_ne_u32 s[90:91], s70, v127
    s_or_b64 vcc, vcc, s[90:91]
    s_cbranch_vccnz K1C1_CS8_SLOW
K1C1_CS8_OK:
    v_add_f32 v108, v108, v110
    v_add_f32 v112, v112, v114
    v_add_f32 v116, v116, v118
    v_add_f32 v120, v120, v122
    ds_read_b128 v[232:235], v30 offset:0
    ds_read_b64_tr_b16 v[56:57], v36 offset:26624
    ds_read_b64_tr_b16 v[58:59], v36 offset:26880
    v_mfma_f32_32x32x16_bf16 v[80:95], v[60:63], v[220:223], v[80:95]
    v_add_f32 v124, v124, v126
    v_mov_b32 v109, v108
    v_mov_b32 v113, v112
    v_mov_b32 v117, v116
    v_mov_b32 v121, v120
    ds_read_b64_tr_b16 v[60:61], v37 offset:26624
    ds_read_b64_tr_b16 v[62:63], v37 offset:26880
    s_waitcnt lgkmcnt(10)
    v_mfma_f32_32x32x16_bf16 v[64:79], v[40:43], v[224:227], v[64:79]
    v_mov_b32 v125, v124
    s_nop 1
    v_permlane32_swap_b32 v108, v109
    v_permlane32_swap_b32 v112, v113
    v_permlane32_swap_b32 v116, v117
    ds_read_b128 v[236:239], v31 offset:0
    ds_read_b64_tr_b16 v[40:41], v36 offset:27648
    ds_read_b64_tr_b16 v[42:43], v36 offset:27904
    v_mfma_f32_32x32x16_bf16 v[80:95], v[44:47], v[224:227], v[80:95]
    v_permlane32_swap_b32 v120, v121
    v_permlane32_swap_b32 v124, v125
    s_nop 1
    v_add_f32 v110, v108, v109
    v_add_f32 v114, v112, v113
    ds_read_b64_tr_b16 v[44:45], v37 offset:27648
    ds_read_b64_tr_b16 v[46:47], v37 offset:27904
    s_waitcnt lgkmcnt(10)
    v_mfma_f32_32x32x16_bf16 v[64:79], v[48:51], v[228:231], v[64:79]
    v_add_f32 v118, v116, v117
    v_add_f32 v122, v120, v121
    v_add_f32 v126, v124, v125
    v_cvt_pk_bf16_f32 v111, v110, v110
    v_cvt_pk_bf16_f32 v115, v114, v114
    s_waitcnt lgkmcnt(0)
    s_barrier
    v_add_u32 v28, 32768, v28
    v_add_u32 v29, 32768, v29
    v_add_u32 v30, 32768, v30
    v_add_u32 v31, 32768, v31
    ds_read_b128 v[240:243], v28 offset:0
    v_add_u32 v36, 32768, v36
    v_add_u32 v37, 32768, v37
    ds_read_b64_tr_b16 v[48:49], v36 offset:24576
    ds_read_b64_tr_b16 v[50:51], v36 offset:24832
    v_mfma_f32_32x32x16_bf16 v[80:95], v[52:55], v[228:231], v[80:95]
    s_add_u32 m0, s75, 49152
    s_add_u32 s84, s82, s57
    buffer_load_dwordx4 v23, s[16:19], s84 offen lds
    v_cvt_pk_bf16_f32 v119, v118, v118
    v_cvt_pk_bf16_f32 v123, v122, v122
    v_cvt_pk_bf16_f32 v127, v126, v126
    v_lshlrev_b32 v111, 16, v111
    v_lshlrev_b32 v115, 16, v115
    ds_read_b64_tr_b16 v[52:53], v37 offset:24576
    ds_read_b64_tr_b16 v[54:55], v37 offset:24832
    v_mfma_f32_32x32x16_bf16 v[64:79], v[56:59], v[232:235], v[64:79]
    s_add_u32 m0, s77, 32768
    s_add_u32 s84, s81, s50
    buffer_load_dwordx4 v24, s[16:19], s84 offen lds
    v_lshlrev_b32 v119, 16, v119
    v_lshlrev_b32 v123, 16, v123
    v_lshlrev_b32 v127, 16, v127
    v_sub_f32 v111, v110, v111
    v_sub_f32 v115, v114, v115
    ds_read_b128 v[244:247], v29 offset:0
    ds_read_b64_tr_b16 v[56:57], v36 offset:25600
    ds_read_b64_tr_b16 v[58:59], v36 offset:25856
    v_mfma_f32_32x32x16_bf16 v[80:95], v[60:63], v[232:235], v[80:95]
    s_add_u32 m0, s77, 33792
    s_add_u32 s84, s84, 28672
    buffer_load_dwordx4 v24, s[16:19], s84 offen lds
    v_sub_f32 v119, v118, v119
    v_sub_f32 v123, v122, v123
    v_sub_f32 v127, v126, v127
    v_cvt_pk_bf16_f32 v108, v110, v111
    v_cvt_pk_bf16_f32 v112, v114, v115
    ds_read_b64_tr_b16 v[60:61], v37 offset:25600
    ds_read_b64_tr_b16 v[62:63], v37 offset:25856
    v_mfma_f32_32x32x16_bf16 v[64:79], v[40:43], v[236:239], v[64:79]
    v_cvt_pk_bf16_f32 v116, v118, v119
    v_cvt_pk_bf16_f32 v120, v122, v123
    v_cvt_pk_bf16_f32 v124, v126, v127
    v_and_b32 v110, 0xffff0000, v108
    v_and_b32 v114, 0xffff0000, v112
    ds_read_b128 v[248:251], v30 offset:0
    ds_read_b64_tr_b16 v[40:41], v36 offset:26624
    ds_read_b64_tr_b16 v[42:43], v36 offset:26880
    v_mfma_f32_32x32x16_bf16 v[80:95], v[44:47], v[236:239], v[80:95]
    v_and_b32 v118, 0xffff0000, v116
    v_and_b32 v122, 0xffff0000, v120
    v_and_b32 v126, 0xffff0000, v124
    v_sub_f32 v111, v111, v110
    v_sub_f32 v115, v115, v114
    ds_read_b64_tr_b16 v[44:45], v37 offset:26624
    ds_read_b64_tr_b16 v[46:47], v37 offset:26880
    s_waitcnt lgkmcnt(10)
    v_mfma_f32_32x32x16_bf16 v[64:79], v[48:51], v[240:243], v[64:79]
    v_sub_f32 v119, v119, v118
    v_sub_f32 v123, v123, v122
    v_sub_f32 v127, v127, v126
    v_cvt_pk_bf16_f32 v109, v111, 0
    v_cvt_pk_bf16_f32 v113, v115, 0
    ds_read_b128 v[252:255], v31 offset:0
    ds_read_b64_tr_b16 v[48:49], v36 offset:27648
    ds_read_b64_tr_b16 v[50:51], v36 offset:27904
    v_mfma_f32_32x32x16_bf16 v[80:95], v[52:55], v[240:243], v[80:95]
    v_cvt_pk_bf16_f32 v117, v119, 0
    v_cvt_pk_bf16_f32 v121, v123, 0
    v_cvt_pk_bf16_f32 v125, v127, 0
    v_lshlrev_b32 v2, 3, v0
    v_add_u32 v2, 160832, v2
    ds_read_b64_tr_b16 v[52:53], v37 offset:27648
    ds_read_b64_tr_b16 v[54:55], v37 offset:27904
    s_waitcnt lgkmcnt(10)
    v_mfma_f32_32x32x16_bf16 v[64:79], v[56:59], v[244:247], v[64:79]
    ds_write_b64 v2, v[108:109] offset:0
    ds_write_b64 v2, v[112:113] offset:512
    ds_write_b64 v2, v[116:117] offset:1024
    ds_write_b64 v2, v[120:121] offset:1536
    ds_write_b64 v2, v[124:125] offset:2048
    s_waitcnt vmcnt(3)
    s_waitcnt lgkmcnt(0)
    s_barrier
    v_add_u32 v25, 131072, v25
    ds_read_b64_tr_b16 v[56:57], v25 offset:0
    ds_read_b64_tr_b16 v[58:59], v25 offset:256
    v_mfma_f32_32x32x16_bf16 v[80:95], v[60:63], v[244:247], v[80:95]
    s_add_u32 m0, s77, 65536
    s_add_u32 s84, s81, s51
    buffer_load_dwordx4 v24, s[16:19], s84 offen lds
    ds_read_b64_tr_b16 v[60:61], v25 offset:1024
    ds_read_b64_tr_b16 v[62:63], v25 offset:1280
    v_mfma_f32_32x32x16_bf16 v[64:79], v[40:43], v[248:251], v[64:79]
    s_add_u32 m0, s77, 66560
    s_add_u32 s84, s84, 28672
    buffer_load_dwordx4 v24, s[16:19], s84 offen lds
    ds_read_b64_tr_b16 v[40:41], v25 offset:2048
    ds_read_b64_tr_b16 v[42:43], v25 offset:2304
    v_mfma_f32_32x32x16_bf16 v[80:95], v[44:47], v[248:251], v[80:95]
    s_add_u32 m0, s77, 81920
    s_add_u32 s84, s81, s52
    buffer_load_dwordx4 v24, s[16:19], s84 offen lds
    ds_read_b64_tr_b16 v[44:45], v25 offset:3072
    ds_read_b64_tr_b16 v[46:47], v25 offset:3328
    v_mfma_f32_32x32x16_bf16 v[64:79], v[48:51], v[252:255], v[64:79]
    s_add_u32 m0, s77, 82944
    s_add_u32 s84, s84, 28672
    buffer_load_dwordx4 v24, s[16:19], s84 offen lds
    ds_read_b64_tr_b16 v[48:49], v25 offset:8192
    ds_read_b64_tr_b16 v[50:51], v25 offset:8448
    v_mfma_f32_32x32x16_bf16 v[80:95], v[52:55], v[252:255], v[80:95]
    s_add_u32 m0, s77, 98304
    s_add_u32 s84, s81, s53
    buffer_load_dwordx4 v24, s[16:19], s84 offen lds
    v_mov_b32 v28, v10
    v_mov_b32 v29, v11
    v_mov_b32 v30, 0
    v_mov_b32 v31, 0
    v_mov_b32 v14, 0
    ds_read_b64_tr_b16 v[52:53], v25 offset:9216
    ds_read_b64_tr_b16 v[54:55], v25 offset:9472
    s_waitcnt lgkmcnt(10)
    v_mfma_f32_32x32x16_bf16 v[96:111], v[56:59], v[128:131], 0
    s_add_u32 m0, s77, 99328
    s_add_u32 s84, s84, 28672
    buffer_load_dwordx4 v24, s[16:19], s84 offen lds
    v_mov_b32 v15, 0
    v_lshlrev_b32 v13, 3, v0
    v_add_u32 v13, 160832, v13
    ds_read_b64 v[12:13], v13 offset:0
    s_waitcnt lgkmcnt(0)
    ds_read_b64_tr_b16 v[56:57], v25 offset:10240
    ds_read_b64_tr_b16 v[58:59], v25 offset:10496
    v_mfma_f32_32x32x16_bf16 v[96:111], v[60:63], v[132:135], v[96:111]
    s_add_u32 m0, s77, 114688
    s_add_u32 s84, s81, s54
    buffer_load_dwordx4 v24, s[16:19], s84 offen lds
    v_mfma_f32_32x32x16_bf16 v[64:79], v[12:15], v[28:31], v[64:79]
    v_lshlrev_b32 v13, 3, v0
    v_add_u32 v13, 160832, v13
    ds_read_b64 v[12:13], v13 offset:512
    s_waitcnt lgkmcnt(0)
    ds_read_b64_tr_b16 v[60:61], v25 offset:11264
    ds_read_b64_tr_b16 v[62:63], v25 offset:11520
    v_mfma_f32_32x32x16_bf16 v[96:111], v[40:43], v[136:139], v[96:111]
    s_add_u32 m0, s77, 115712
    s_add_u32 s84, s84, 28672
    buffer_load_dwordx4 v24, s[16:19], s84 offen lds
    v_mfma_f32_32x32x16_bf16 v[80:95], v[12:15], v[28:31], v[80:95]
    s_nop 7
    v_mul_f32 v6, v64, v20
    v_mul_f32 v7, v65, v20
    v_exp_f32 v6, v6
    ds_read_b64_tr_b16 v[40:41], v25 offset:16384
    ds_read_b64_tr_b16 v[42:43], v25 offset:16640
    v_mfma_f32_32x32x16_bf16 v[96:111], v[44:47], v[140:143], v[96:111]
    v_exp_f32 v7, v7
    v_mul_f32 v8, v64, v72
    v_mul_f32 v9, v65, v73
    v_fma_f32 v6, v6, v21, v21
    v_fma_f32 v7, v7, v21, v21
    ds_read_b64_tr_b16 v[44:45], v25 offset:17408
    ds_read_b64_tr_b16 v[46:47], v25 offset:17664
    v_mfma_f32_32x32x16_bf16 v[96:111], v[48:51], v[144:147], v[96:111]
    v_rcp_f32 v6, v6
    v_rcp_f32 v7, v7
    s_nop 0
    v_mul_f32 v8, v8, v6
    v_mul_f32 v9, v9, v7
    ds_read_b64_tr_b16 v[48:49], v25 offset:18432
    ds_read_b64_tr_b16 v[50:51], v25 offset:18688
    v_mfma_f32_32x32x16_bf16 v[96:111], v[52:55], v[148:151], v[96:111]
    v_cvt_pk_bf16_f32 v2, v8, v9
    v_mul_f32 v6, v66, v20
    v_mul_f32 v7, v67, v20
    v_exp_f32 v6, v6
    v_exp_f32 v7, v7
    ds_read_b64_tr_b16 v[52:53], v25 offset:19456
    ds_read_b64_tr_b16 v[54:55], v25 offset:19712
    v_mfma_f32_32x32x16_bf16 v[96:111], v[56:59], v[152:155], v[96:111]
    v_mul_f32 v8, v66, v74
    v_mul_f32 v9, v67, v75
    v_fma_f32 v6, v6, v21, v21
    v_fma_f32 v7, v7, v21, v21
    v_rcp_f32 v6, v6
    v_subrev_u32 v25, 131072, v25
    ds_read_b64_tr_b16 v[56:57], v25 offset:0
    ds_read_b64_tr_b16 v[58:59], v25 offset:256
    s_waitcnt lgkmcnt(10)
    v_mfma_f32_32x32x16_bf16 v[96:111], v[60:63], v[156:159], v[96:111]
    v_rcp_f32 v7, v7
    s_nop 0
    v_mul_f32 v8, v8, v6
    v_mul_f32 v9, v9, v7
    v_cvt_pk_bf16_f32 v3, v8, v9
    ds_read_b64_tr_b16 v[60:61], v25 offset:1024
    ds_read_b64_tr_b16 v[62:63], v25 offset:1280
    s_waitcnt lgkmcnt(10)
    v_mfma_f32_32x32x16_bf16 v[96:111], v[40:43], v[160:163], v[96:111]
    v_mul_f32 v6, v68, v20
    v_mul_f32 v7, v69, v20
    v_exp_f32 v6, v6
    v_exp_f32 v7, v7
    v_mul_f32 v8, v68, v76
    ds_read_b64_tr_b16 v[40:41], v25 offset:2048
    ds_read_b64_tr_b16 v[42:43], v25 offset:2304
    s_waitcnt lgkmcnt(10)
    v_mfma_f32_32x32x16_bf16 v[96:111], v[44:47], v[164:167], v[96:111]
    v_mul_f32 v9, v69, v77
    v_fma_f32 v6, v6, v21, v21
    v_fma_f32 v7, v7, v21, v21
    v_rcp_f32 v6, v6
    v_rcp_f32 v7, v7
    ds_read_b64_tr_b16 v[44:45], v25 offset:3072
    ds_read_b64_tr_b16 v[46:47], v25 offset:3328
    s_waitcnt lgkmcnt(10)
    v_mfma_f32_32x32x16_bf16 v[96:111], v[48:51], v[168:171], v[96:111]
    s_nop 0
    v_mul_f32 v8, v8, v6
    v_mul_f32 v9, v9, v7
    v_cvt_pk_bf16_f32 v4, v8, v9
    v_mul_f32 v6, v70, v20
    s_waitcnt vmcnt(10)
    s_waitcnt lgkmcnt(0)
    s_barrier
    ds_read_b64_tr_b16 v[48:49], v25 offset:8192
    ds_read_b64_tr_b16 v[50:51], v25 offset:8448
    v_mfma_f32_32x32x16_bf16 v[96:111], v[52:55], v[172:175], v[96:111]
    s_add_u32 m0, s77, 131072
    s_add_u32 s84, s81, s55
    buffer_load_dwordx4 v24, s[16:19], s84 offen lds
    v_mul_f32 v7, v71, v20
    v_exp_f32 v6, v6
    v_exp_f32 v7, v7
    v_mul_f32 v8, v70, v78
    v_mul_f32 v9, v71, v79
    ds_read_b64_tr_b16 v[52:53], v25 offset:9216
    ds_read_b64_tr_b16 v[54:55], v25 offset:9472
    v_mfma_f32_32x32x16_bf16 v[96:111], v[56:59], v[176:179], v[96:111]
    s_add_u32 m0, s77, 132096
    s_add_u32 s84, s84, 28672
    buffer_load_dwordx4 v24, s[16:19], s84 offen lds
    v_fma_f32 v6, v6, v21, v21
    v_fma_f32 v7, v7, v21, v21
    v_rcp_f32 v6, v6
    v_rcp_f32 v7, v7
    s_lshl_b32 s90, s80, 5
    ds_read_b64_tr_b16 v[56:57], v25 offset:10240
    ds_read_b64_tr_b16 v[58:59], v25 offset:10496
    v_mfma_f32_32x32x16_bf16 v[96:111], v[60:63], v[180:183], v[96:111]
    v_mul_f32 v8, v8, v6
    v_mul_f32 v9, v9, v7
    v_cvt_pk_bf16_f32 v5, v8, v9
    s_add_u32 s90, s90, s68
    s_add_u32 s90, s90, 65536
    ds_read_b64_tr_b16 v[60:61], v25 offset:11264
    ds_read_b64_tr_b16 v[62:63], v25 offset:11520
    v_mfma_f32_32x32x16_bf16 v[96:111], v[40:43], v[184:187], v[96:111]
    buffer_store_dwordx4 v[2:5], v27, s[20:23], s90 offen sc0 sc1
    s_nop 0
    v_mul_f32 v6, v80, v20
    v_mul_f32 v7, v81, v20
    v_exp_f32 v6, v6
    ds_read_b64_tr_b16 v[40:41], v25 offset:16384
    ds_read_b64_tr_b16 v[42:43], v25 offset:16640
    v_mfma_f32_32x32x16_bf16 v[96:111], v[44:47], v[188:191], v[96:111]
    v_exp_f32 v7, v7
    v_mul_f32 v8, v80, v88
    v_mul_f32 v9, v81, v89
    v_fma_f32 v6, v6, v21, v21
    v_fma_f32 v7, v7, v21, v21
    ds_read_b64_tr_b16 v[44:45], v25 offset:17408
    ds_read_b64_tr_b16 v[46:47], v25 offset:17664
    s_waitcnt lgkmcnt(10)
    v_mfma_f32_32x32x16_bf16 v[96:111], v[48:51], v[192:195], v[96:111]
    v_rcp_f32 v6, v6
    v_rcp_f32 v7, v7
    s_nop 0
    v_mul_f32 v8, v8, v6
    v_mul_f32 v9, v9, v7
    ds_read_b64_tr_b16 v[48:49], v25 offset:18432
    ds_read_b64_tr_b16 v[50:51], v25 offset:18688
    s_waitcnt lgkmcnt(10)
    v_mfma_f32_32x32x16_bf16 v[96:111], v[52:55], v[196:199], v[96:111]
    v_cvt_pk_bf16_f32 v2, v8, v9
    v_mul_f32 v6, v82, v20
    v_mul_f32 v7, v83, v20
    v_exp_f32 v6, v6
    v_exp_f32 v7, v7
    ds_read_b64_tr_b16 v[52:53], v25 offset:19456
    ds_read_b64_tr_b16 v[54:55], v25 offset:19712
    s_waitcnt lgkmcnt(10)
    v_mfma_f32_32x32x16_bf16 v[96:111], v[56:59], v[200:203], v[96:111]
    v_mul_f32 v8, v82, v90
    v_mul_f32 v9, v83, v91
    v_fma_f32 v6, v6, v21, v21
    v_fma_f32 v7, v7, v21, v21
    v_rcp_f32 v6, v6
    ds_read_b64_tr_b16 v[56:57], v25 offset:24576
    ds_read_b64_tr_b16 v[58:59], v25 offset:24832
    s_waitcnt lgkmcnt(10)
    v_mfma_f32_32x32x16_bf16 v[96:111], v[60:63], v[204:207], v[96:111]
    v_rcp_f32 v7, v7
    s_nop 0
    v_mul_f32 v8, v8, v6
    v_mul_f32 v9, v9, v7
    v_cvt_pk_bf16_f32 v3, v8, v9
    ds_read_b64_tr_b16 v[60:61], v25 offset:25600
    ds_read_b64_tr_b16 v[62:63], v25 offset:25856
    s_waitcnt lgkmcnt(10)
    v_mfma_f32_32x32x16_bf16 v[96:111], v[40:43], v[208:211], v[96:111]
    v_mul_f32 v6, v84, v20
    v_mul_f32 v7, v85, v20
    v_exp_f32 v6, v6
    v_exp_f32 v7, v7
    v_mul_f32 v8, v84, v92
    ds_read_b64_tr_b16 v[40:41], v25 offset:26624
    ds_read_b64_tr_b16 v[42:43], v25 offset:26880
    s_waitcnt lgkmcnt(10)
    v_mfma_f32_32x32x16_bf16 v[96:111], v[44:47], v[212:215], v[96:111]
    v_mul_f32 v9, v85, v93
    v_fma_f32 v6, v6, v21, v21
    v_fma_f32 v7, v7, v21, v21
    v_rcp_f32 v6, v6
    v_rcp_f32 v7, v7
    ds_read_b64_tr_b16 v[44:45], v25 offset:27648
    ds_read_b64_tr_b16 v[46:47], v25 offset:27904
    s_waitcnt lgkmcnt(10)
    v_mfma_f32_32x32x16_bf16 v[96:111], v[48:51], v[216:219], v[96:111]
    s_nop 0
    v_mul_f32 v8, v8, v6
    v_mul_f32 v9, v9, v7
    v_cvt_pk_bf16_f32 v4, v8, v9
    v_mul_f32 v6, v86, v20
    v_add_u32 v25, 32768, v25
    ds_read_b64_tr_b16 v[48:49], v25 offset:16384
    ds_read_b64_tr_b16 v[50:51], v25 offset:16640
    s_waitcnt lgkmcnt(10)
    v_mfma_f32_32x32x16_bf16 v[96:111], v[52:55], v[220:223], v[96:111]
    v_mul_f32 v7, v87, v20
    v_exp_f32 v6, v6
    v_exp_f32 v7, v7
    v_mul_f32 v8, v86, v94
    v_mul_f32 v9, v87, v95
    ds_read_b64_tr_b16 v[52:53], v25 offset:17408
    ds_read_b64_tr_b16 v[54:55], v25 offset:17664
    s_waitcnt lgkmcnt(10)
    v_mfma_f32_32x32x16_bf16 v[96:111], v[56:59], v[224:227], v[96:111]
    v_fma_f32 v6, v6, v21, v21
    v_fma_f32 v7, v7, v21, v21
    v_rcp_f32 v6, v6
    v_rcp_f32 v7, v7
    s_lshl_b32 s90, s80, 5
    ds_read_b64_tr_b16 v[56:57], v25 offset:18432
    ds_read_b64_tr_b16 v[58:59], v25 offset:18688
    s_waitcnt lgkmcnt(10)
    v_mfma_f32_32x32x16_bf16 v[96:111], v[60:63], v[228:231], v[96:111]
    v_mul_f32 v8, v8, v6
    v_mul_f32 v9, v9, v7
    v_cvt_pk_bf16_f32 v5, v8, v9
    s_add_u32 s90, s90, s68
    s_add_u32 s90, s90, 66560
    ds_read_b64_tr_b16 v[60:61], v25 offset:19456
    ds_read_b64_tr_b16 v[62:63], v25 offset:19712
    s_waitcnt lgkmcnt(10)
    v_mfma_f32_32x32x16_bf16 v[96:111], v[40:43], v[232:235], v[96:111]
    buffer_store_dwordx4 v[2:5], v27, s[20:23], s90 offen sc0 sc1
    s_nop 0
    s_waitcnt vmcnt(4)
    s_waitcnt lgkmcnt(0)
    s_barrier
    v_add_u32 v38, 32768, v38
    v_add_u32 v39, 32768, v39
    ds_read_b64_tr_b16 v[40:41], v38 offset:0
    ds_read_b64_tr_b16 v[42:43], v38 offset:512
    v_mfma_f32_32x32x16_bf16 v[96:111], v[44:47], v[236:239], v[96:111]
    s_add_u32 m0, s77, 0
    s_add_u32 s84, s81, s56
    buffer_load_dwordx4 v24, s[16:19], s84 offen lds
    ds_read_b64_tr_b16 v[44:45], v38 offset:2048
    ds_read_b64_tr_b16 v[46:47], v38 offset:2560
    v_mfma_f32_32x32x16_bf16 v[96:111], v[48:51], v[240:243], v[96:111]
    s_add_u32 m0, s77, 1024
    s_add_u32 s84, s84, 28672
    buffer_load_dwordx4 v24, s[16:19], s84 offen lds
    ds_read_b64_tr_b16 v[48:49], v38 offset:4096
    ds_read_b64_tr_b16 v[50:51], v38 offset:4608
    v_mfma_f32_32x32x16_bf16 v[96:111], v[52:55], v[244:247], v[96:111]
    s_add_u32 m0, s77, 16384
    s_add_u32 s84, s81, s57
    buffer_load_dwordx4 v24, s[16:19], s84 offen lds
    ds_read_b64_tr_b16 v[52:53], v38 offset:6144
    ds_read_b64_tr_b16 v[54:55], v38 offset:6656
    v_mfma_f32_32x32x16_bf16 v[96:111], v[56:59], v[248:251], v[96:111]
    s_add_u32 m0, s77, 17408
    s_add_u32 s84, s84, 28672
    buffer_load_dwordx4 v24, s[16:19], s84 offen lds
    v_add_u32 v38, 32768, v38
    v_add_u32 v39, 32768, v39
    ds_read_b64_tr_b16 v[56:57], v38 offset:0
    ds_read_b64_tr_b16 v[58:59], v38 offset:512
    v_mfma_f32_32x32x16_bf16 v[96:111], v[60:63], v[252:255], v[96:111]
    v_lshlrev_b32 v13, 3, v0
    v_add_u32 v13, 160832, v13
    ds_read_b64 v[12:13], v13 offset:2048
    s_waitcnt lgkmcnt(0)
    v_mfma_f32_32x32x16_bf16 v[96:111], v[12:15], v[28:31], v[96:111]
    ds_read_b64_tr_b16 v[60:61], v38 offset:2048
    ds_read_b64_tr_b16 v[62:63], v38 offset:2560
    v_mfma_f32_32x32x16_bf16 v[112:127], v[40:43], v[128:131], 0
    s_nop 7
    s_nop 3
    v_mul_f32 v6, v96, v20
    v_mul_f32 v7, v97, v20
    v_exp_f32 v6, v6
    ds_read_b64_tr_b16 v[40:41], v38 offset:4096
    ds_read_b64_tr_b16 v[42:43], v38 offset:4608
    v_mfma_f32_32x32x16_bf16 v[112:127], v[44:47], v[132:135], v[112:127]
    v_exp_f32 v7, v7
    v_mul_f32 v8, v96, v104
    v_mul_f32 v9, v97, v105
    v_fma_f32 v6, v6, v21, v21
    v_fma_f32 v7, v7, v21, v21
    ds_read_b64_tr_b16 v[44:45], v38 offset:6144
    ds_read_b64_tr_b16 v[46:47], v38 offset:6656
    v_mfma_f32_32x32x16_bf16 v[112:127], v[48:51], v[136:139], v[112:127]
    v_rcp_f32 v6, v6
    v_rcp_f32 v7, v7
    s_nop 0
    v_mul_f32 v8, v8, v6
    v_mul_f32 v9, v9, v7
    ds_read_b64_tr_b16 v[48:49], v38 offset:16384
    ds_read_b64_tr_b16 v[50:51], v38 offset:16896
    v_mfma_f32_32x32x16_bf16 v[112:127], v[52:55], v[140:143], v[112:127]
    v_cvt_pk_bf16_f32 v2, v8, v9
    v_mul_f32 v6, v98, v20
    v_mul_f32 v7, v99, v20
    v_exp_f32 v6, v6
    v_exp_f32 v7, v7
    ds_read_b64_tr_b16 v[52:53], v38 offset:18432
    ds_read_b64_tr_b16 v[54:55], v38 offset:18944
    v_mfma_f32_32x32x16_bf16 v[112:127], v[56:59], v[144:147], v[112:127]
    v_mul_f32 v8, v98, v106
    v_mul_f32 v9, v99, v107
    v_fma_f32 v6, v6, v21, v21
    v_fma_f32 v7, v7, v21, v21
    v_rcp_f32 v6, v6
    ds_read_b64_tr_b16 v[56:57], v38 offset:20480
    ds_read_b64_tr_b16 v[58:59], v38 offset:20992
    s_waitcnt lgkmcnt(10)
    v_mfma_f32_32x32x16_bf16 v[112:127], v[60:63], v[148:151], v[112:127]
    v_rcp_f32 v7, v7
    s_nop 0
    v_mul_f32 v8, v8, v6
    v_mul_f32 v9, v9, v7
    v_cvt_pk_bf16_f32 v3, v8, v9
    ds_read_b64_tr_b16 v[60:61], v38 offset:22528
    ds_read_b64_tr_b16 v[62:63], v38 offset:23040
    s_waitcnt lgkmcnt(10)
    v_mfma_f32_32x32x16_bf16 v[112:127], v[40:43], v[152:155], v[112:127]
    v_mul_f32 v6, v100, v20
    v_mul_f32 v7, v101, v20
    v_exp_f32 v6, v6
    v_exp_f32 v7, v7
    v_mul_f32 v8, v100, v108
    v_add_u32 v38, 32768, v38
    v_add_u32 v39, 32768, v39
    ds_read_b64_tr_b16 v[40:41], v38 offset:0
    ds_read_b64_tr_b16 v[42:43], v38 offset:512
    s_waitcnt lgkmcnt(10)
    v_mfma_f32_32x32x16_bf16 v[112:127], v[44:47], v[156:159], v[112:127]
    v_mul_f32 v9, v101, v109
    v_fma_f32 v6, v6, v21, v21
    v_fma_f32 v7, v7, v21, v21
    v_rcp_f32 v6, v6
    v_rcp_f32 v7, v7
    ds_read_b64_tr_b16 v[44:45], v38 offset:2048
    ds_read_b64_tr_b16 v[46:47], v38 offset:2560
    s_waitcnt lgkmcnt(10)
    v_mfma_f32_32x32x16_bf16 v[112:127], v[48:51], v[160:163], v[112:127]
    s_nop 0
    v_mul_f32 v8, v8, v6
    v_mul_f32 v9, v9, v7
    v_cvt_pk_bf16_f32 v4, v8, v9
    v_mul_f32 v6, v102, v20
    ds_read_b64_tr_b16 v[48:49], v38 offset:4096
    ds_read_b64_tr_b16 v[50:51], v38 offset:4608
    s_waitcnt lgkmcnt(10)
    v_mfma_f32_32x32x16_bf16 v[112:127], v[52:55], v[164:167], v[112:127]
    v_mul_f32 v7, v103, v20
    v_exp_f32 v6, v6
    v_exp_f32 v7, v7
    v_mul_f32 v8, v102, v110
    v_mul_f32 v9, v103, v111
    ds_read_b64_tr_b16 v[52:53], v38 offset:6144
    ds_read_b64_tr_b16 v[54:55], v38 offset:6656
    s_waitcnt lgkmcnt(10)
    v_mfma_f32_32x32x16_bf16 v[112:127], v[56:59], v[168:171], v[112:127]
    v_fma_f32 v6, v6, v21, v21
    v_fma_f32 v7, v7, v21, v21
    v_rcp_f32 v6, v6
    v_rcp_f32 v7, v7
    s_lshl_b32 s90, s79, 5
    ds_read_b64_tr_b16 v[56:57], v38 offset:16384
    ds_read_b64_tr_b16 v[58:59], v38 offset:16896
    s_waitcnt lgkmcnt(10)
    v_mfma_f32_32x32x16_bf16 v[112:127], v[60:63], v[172:175], v[112:127]
    v_mul_f32 v8, v8, v6
    v_mul_f32 v9, v9, v7
    v_cvt_pk_bf16_f32 v5, v8, v9
    s_add_u32 s90, s90, s68
    s_add_u32 s90, s90, 65536
    ds_read_b64_tr_b16 v[60:61], v38 offset:18432
    ds_read_b64_tr_b16 v[62:63], v38 offset:18944
    s_waitcnt lgkmcnt(10)
    v_mfma_f32_32x32x16_bf16 v[112:127], v[40:43], v[176:179], v[112:127]
    buffer_store_dwordx4 v[2:5], v27, s[20:23], s90 offen sc0 sc1
    s_nop 0
    ds_read_b64_tr_b16 v[40:41], v38 offset:20480
    ds_read_b64_tr_b16 v[42:43], v38 offset:20992
    s_waitcnt lgkmcnt(10)
    v_mfma_f32_32x32x16_bf16 v[112:127], v[44:47], v[180:183], v[112:127]
    ds_read_b64_tr_b16 v[44:45], v38 offset:22528
    ds_read_b64_tr_b16 v[46:47], v38 offset:23040
    s_waitcnt lgkmcnt(10)
    v_mfma_f32_32x32x16_bf16 v[112:127], v[48:51], v[184:187], v[112:127]
    s_waitcnt vmcnt(7)
    s_waitcnt lgkmcnt(0)
    s_barrier
    v_add_u32 v38, 32768, v38
    v_add_u32 v39, 32768, v39
    ds_read_b64_tr_b16 v[48:49], v38 offset:0
    ds_read_b64_tr_b16 v[50:51], v38 offset:512
    v_mfma_f32_32x32x16_bf16 v[112:127], v[52:55], v[188:191], v[112:127]
    ds_read_b64_tr_b16 v[52:53], v38 offset:2048
    ds_read_b64_tr_b16 v[54:55], v38 offset:2560
    v_mfma_f32_32x32x16_bf16 v[112:127], v[56:59], v[192:195], v[112:127]
    ds_read_b64_tr_b16 v[56:57], v38 offset:4096
    ds_read_b64_tr_b16 v[58:59], v38 offset:4608
    v_mfma_f32_32x32x16_bf16 v[112:127], v[60:63], v[196:199], v[112:127]
    ds_read_b64_tr_b16 v[60:61], v38 offset:6144
    ds_read_b64_tr_b16 v[62:63], v38 offset:6656
    v_mfma_f32_32x32x16_bf16 v[112:127], v[40:43], v[200:203], v[112:127]
    s_waitcnt vmcnt(1)
    s_waitcnt lgkmcnt(0)
    s_barrier
    v_subrev_u32 v38, 131072, v38
    v_subrev_u32 v39, 131072, v39
    ds_read_b64_tr_b16 v[40:41], v38 offset:0
    ds_read_b64_tr_b16 v[42:43], v38 offset:512
    v_mfma_f32_32x32x16_bf16 v[112:127], v[44:47], v[204:207], v[112:127]
    ds_read_b64_tr_b16 v[44:45], v38 offset:2048
    ds_read_b64_tr_b16 v[46:47], v38 offset:2560
    v_mfma_f32_32x32x16_bf16 v[112:127], v[48:51], v[208:211], v[112:127]
    ds_read_b64_tr_b16 v[48:49], v38 offset:4096
    ds_read_b64_tr_b16 v[50:51], v38 offset:4608
    v_mfma_f32_32x32x16_bf16 v[112:127], v[52:55], v[212:215], v[112:127]
    ds_read_b64_tr_b16 v[52:53], v38 offset:6144
    ds_read_b64_tr_b16 v[54:55], v38 offset:6656
    v_mfma_f32_32x32x16_bf16 v[112:127], v[56:59], v[216:219], v[112:127]
    ds_read_b64_tr_b16 v[56:57], v38 offset:16384
    ds_read_b64_tr_b16 v[58:59], v38 offset:16896
    v_mfma_f32_32x32x16_bf16 v[112:127], v[60:63], v[220:223], v[112:127]
    ds_read_b64_tr_b16 v[60:61], v38 offset:18432
    ds_read_b64_tr_b16 v[62:63], v38 offset:18944
    s_waitcnt lgkmcnt(10)
    v_mfma_f32_32x32x16_bf16 v[112:127], v[40:43], v[224:227], v[112:127]
    ds_read_b64_tr_b16 v[40:41], v38 offset:20480
    ds_read_b64_tr_b16 v[42:43], v38 offset:20992
    s_waitcnt lgkmcnt(10)
    v_mfma_f32_32x32x16_bf16 v[112:127], v[44:47], v[228:231], v[112:127]
    ds_read_b64_tr_b16 v[44:45], v38 offset:22528
    ds_read_b64_tr_b16 v[46:47], v38 offset:23040
    s_waitcnt lgkmcnt(10)
    v_mfma_f32_32x32x16_bf16 v[112:127], v[48:51], v[232:235], v[112:127]
    v_add_u32 v38, 32768, v38
    v_add_u32 v39, 32768, v39
    ds_read_b64_tr_b16 v[48:49], v39 offset:0
    ds_read_b64_tr_b16 v[50:51], v39 offset:512
    s_waitcnt lgkmcnt(10)
    v_mfma_f32_32x32x16_bf16 v[112:127], v[52:55], v[236:239], v[112:127]
    ds_read_b64_tr_b16 v[52:53], v39 offset:2048
    ds_read_b64_tr_b16 v[54:55], v39 offset:2560
    s_waitcnt lgkmcnt(10)
    v_mfma_f32_32x32x16_bf16 v[112:127], v[56:59], v[240:243], v[112:127]
    ds_read_b64_tr_b16 v[56:57], v39 offset:4096
    ds_read_b64_tr_b16 v[58:59], v39 offset:4608
    s_waitcnt lgkmcnt(10)
    v_mfma_f32_32x32x16_bf16 v[112:127], v[60:63], v[244:247], v[112:127]
    ds_read_b64_tr_b16 v[60:61], v39 offset:6144
    ds_read_b64_tr_b16 v[62:63], v39 offset:6656
    s_waitcnt lgkmcnt(10)
    v_mfma_f32_32x32x16_bf16 v[112:127], v[40:43], v[248:251], v[112:127]
    v_add_u32 v38, 32768, v38
    v_add_u32 v39, 32768, v39
    ds_read_b64_tr_b16 v[40:41], v39 offset:0
    ds_read_b64_tr_b16 v[42:43], v39 offset:512
    s_waitcnt lgkmcnt(10)
    v_mfma_f32_32x32x16_bf16 v[112:127], v[44:47], v[252:255], v[112:127]
    v_lshlrev_b32 v13, 3, v0
    v_add_u32 v13, 160832, v13
    ds_read_b64 v[12:13], v13 offset:1024
    s_waitcnt lgkmcnt(0)
    v_mfma_f32_32x32x16_bf16 v[112:127], v[12:15], v[28:31], v[112:127]
    ds_read_b64_tr_b16 v[44:45], v39 offset:2048
    ds_read_b64_tr_b16 v[46:47], v39 offset:2560
    s_and_b32 s94, s2, 7
    s_lshr_b32 s95, s2, 3
    s_and_b32 s94, s94, 1
    s_lshl_b32 s94, s94, 2
    s_and_b32 s95, s95, 3
    s_add_u32 s94, s94, s95
    s_lshl_b32 s94, s94, 5
    v_and_b32 v32, 31, v0
    v_add_u32 v32, s94, v32
    v_lshlrev_b32 v32, 4, v32
    s_mov_b32 s94, 540680
K1_WP1:
    buffer_load_dword v33, v32, s[24:27], s94 offen sc1
    s_waitcnt vmcnt(0)
    v_cmp_ne_u32 vcc, s70, v33
    s_cbranch_vccz K1_WP1_OK
    s_add_u32 s32, s32, 1
    s_cmp_lt_u32 s32, 20000
    s_cbranch_scc1 K1_WP1
K1_WP1_OK:
    s_and_b32 s44, s2, 7
    s_lshr_b32 s45, s2, 3
    s_and_b32 s44, s44, 1
    s_lshl_b32 s44, s44, 2
    s_and_b32 s45, s45, 3
    s_add_u32 s44, s44, s45
    s_add_u32 s12, s66, 11534336
    s_addc_u32 s13, s67, 0
    s_mov_b32 s14, 2883584
    s_mov_b32 s15, 0x00020000
    s_mul_i32 s46, s3, 22528
    s_mul_i32 s44, s44, 360448
    s_add_u32 s44, s44, s46
    s_add_u32 s45, s44, 180224
    v_mfma_f32_32x32x16_bf16 v[64:79], v[48:51], v[128:131], 0
    s_nop 7
    s_nop 3
    v_mul_f32 v6, v112, v20
    v_mul_f32 v7, v113, v20
    v_exp_f32 v6, v6
    ds_read_b64_tr_b16 v[48:49], v39 offset:4096
    ds_read_b64_tr_b16 v[50:51], v39 offset:4608
    v_mfma_f32_32x32x16_bf16 v[64:79], v[52:55], v[132:135], v[64:79]
    buffer_load_dwordx4 v[128:131], v27, s[12:15], s44 offen offset:0 sc1
    v_exp_f32 v7, v7
    v_mul_f32 v8, v112, v120
    v_mul_f32 v9, v113, v121
    v_fma_f32 v6, v6, v21, v21
    v_fma_f32 v7, v7, v21, v21
    ds_read_b64_tr_b16 v[52:53], v39 offset:6144
    ds_read_b64_tr_b16 v[54:55], v39 offset:6656
    v_mfma_f32_32x32x16_bf16 v[64:79], v[56:59], v[136:139], v[64:79]
    buffer_load_dwordx4 v[132:135], v27, s[12:15], s45 offen offset:0 sc1
    v_rcp_f32 v6, v6
    v_rcp_f32 v7, v7
    s_nop 0
    v_mul_f32 v8, v8, v6
    v_mul_f32 v9, v9, v7
    ds_read_b64_tr_b16 v[56:57], v39 offset:16384
    ds_read_b64_tr_b16 v[58:59], v39 offset:16896
    v_mfma_f32_32x32x16_bf16 v[64:79], v[60:63], v[140:143], v[64:79]
    buffer_load_dwordx4 v[136:139], v27, s[12:15], s44 offen offset:1024 sc1
    v_cvt_pk_bf16_f32 v2, v8, v9
    v_mul_f32 v6, v114, v20
    v_mul_f32 v7, v115, v20
    v_exp_f32 v6, v6
    v_exp_f32 v7, v7
    ds_read_b64_tr_b16 v[60:61], v39 offset:18432
    ds_read_b64_tr_b16 v[62:63], v39 offset:18944
    v_mfma_f32_32x32x16_bf16 v[64:79], v[40:43], v[144:147], v[64:79]
    buffer_load_dwordx4 v[140:143], v27, s[12:15], s45 offen offset:1024 sc1
    v_mul_f32 v8, v114, v122
    v_mul_f32 v9, v115, v123
    v_fma_f32 v6, v6, v21, v21
    v_fma_f32 v7, v7, v21, v21
    v_rcp_f32 v6, v6
    ds_read_b64_tr_b16 v[40:41], v39 offset:20480
    ds_read_b64_tr_b16 v[42:43], v39 offset:20992
    s_waitcnt lgkmcnt(10)
    v_mfma_f32_32x32x16_bf16 v[64:79], v[44:47], v[148:151], v[64:79]
    buffer_load_dwordx4 v[144:147], v27, s[12:15], s44 offen offset:2048 sc1
    v_rcp_f32 v7, v7
    s_nop 0
    v_mul_f32 v8, v8, v6
    v_mul_f32 v9, v9, v7
    v_cvt_pk_bf16_f32 v3, v8, v9
    ds_read_b64_tr_b16 v[44:45], v39 offset:22528
    ds_read_b64_tr_b16 v[46:47], v39 offset:23040
    s_waitcnt lgkmcnt(10)
    v_mfma_f32_32x32x16_bf16 v[64:79], v[48:51], v[152:155], v[64:79]
    buffer_load_dwordx4 v[148:151], v27, s[12:15], s45 offen offset:2048 sc1
    v_mul_f32 v6, v116, v20
    v_mul_f32 v7, v117, v20
    v_exp_f32 v6, v6
    v_exp_f32 v7, v7
    v_mul_f32 v8, v116, v124
    v_add_u32 v38, 32768, v38
    v_add_u32 v39, 32768, v39
    ds_read_b64_tr_b16 v[48:49], v39 offset:0
    ds_read_b64_tr_b16 v[50:51], v39 offset:512
    s_waitcnt lgkmcnt(10)
    v_mfma_f32_32x32x16_bf16 v[64:79], v[52:55], v[156:159], v[64:79]
    buffer_load_dwordx4 v[152:155], v27, s[12:15], s44 offen offset:3072 sc1
    v_mul_f32 v9, v117, v125
    v_fma_f32 v6, v6, v21, v21
    v_fma_f32 v7, v7, v21, v21
    v_rcp_f32 v6, v6
    v_rcp_f32 v7, v7
    ds_read_b64_tr_b16 v[52:53], v39 offset:2048
    ds_read_b64_tr_b16 v[54:55], v39 offset:2560
    s_waitcnt lgkmcnt(10)
    v_mfma_f32_32x32x16_bf16 v[64:79], v[56:59], v[160:163], v[64:79]
    buffer_load_dwordx4 v[156:159], v27, s[12:15], s45 offen offset:3072 sc1
    s_nop 0
    v_mul_f32 v8, v8, v6
    v_mul_f32 v9, v9, v7
    v_cvt_pk_bf16_f32 v4, v8, v9
    v_mul_f32 v6, v118, v20
    ds_read_b64_tr_b16 v[56:57], v39 offset:4096
    ds_read_b64_tr_b16 v[58:59], v39 offset:4608
    s_waitcnt lgkmcnt(10)
    v_mfma_f32_32x32x16_bf16 v[64:79], v[60:63], v[164:167], v[64:79]
    s_add_u32 s46, s44, 4096
    buffer_load_dwordx4 v[160:163], v27, s[12:15], s46 offen offset:0 sc1
    v_mul_f32 v7, v119, v20
    v_exp_f32 v6, v6
    v_exp_f32 v7, v7
    v_mul_f32 v8, v118, v126
    v_mul_f32 v9, v119, v127
    ds_read_b64_tr_b16 v[60:61], v39 offset:6144
    ds_read_b64_tr_b16 v[62:63], v39 offset:6656
    s_waitcnt lgkmcnt(10)
    v_mfma_f32_32x32x16_bf16 v[64:79], v[40:43], v[168:171], v[64:79]
    s_add_u32 s46, s45, 4096
    buffer_load_dwordx4 v[164:167], v27, s[12:15], s46 offen offset:0 sc1
    v_fma_f32 v6, v6, v21, v21
    v_fma_f32 v7, v7, v21, v21
    v_rcp_f32 v6, v6
    v_rcp_f32 v7, v7
    s_lshl_b32 s90, s81, 5
    ds_read_b64_tr_b16 v[40:41], v39 offset:16384
    ds_read_b64_tr_b16 v[42:43], v39 offset:16896
    s_waitcnt lgkmcnt(10)
    v_mfma_f32_32x32x16_bf16 v[64:79], v[44:47], v[172:175], v[64:79]
    s_add_u32 s46, s44, 4096
    buffer_load_dwordx4 v[168:171], v27, s[12:15], s46 offen offset:1024 sc1
    v_mul_f32 v8, v8, v6
    v_mul_f32 v9, v9, v7
    v_cvt_pk_bf16_f32 v5, v8, v9
    s_add_u32 s90, s90, s68
    s_add_u32 s90, s90, 67584
    ds_read_b64_tr_b16 v[44:45], v39 offset:18432
    ds_read_b64_tr_b16 v[46:47], v39 offset:18944
    s_waitcnt lgkmcnt(10)
    v_mfma_f32_32x32x16_bf16 v[64:79], v[48:51], v[176:179], v[64:79]
    s_add_u32 s46, s45, 4096
    buffer_load_dwordx4 v[172:175], v27, s[12:15], s46 offen offset:1024 sc1
    buffer_store_dwordx4 v[2:5], v27, s[20:23], s90 offen sc0 sc1
    s_nop 0
    ds_read_b64_tr_b16 v[48:49], v39 offset:20480
    ds_read_b64_tr_b16 v[50:51], v39 offset:20992
    s_waitcnt lgkmcnt(10)
    v_mfma_f32_32x32x16_bf16 v[64:79], v[52:55], v[180:183], v[64:79]
    s_add_u32 s46, s44, 4096
    buffer_load_dwordx4 v[176:179], v27, s[12:15], s46 offen offset:2048 sc1
    ds_read_b64_tr_b16 v[52:53], v39 offset:22528
    ds_read_b64_tr_b16 v[54:55], v39 offset:23040
    s_waitcnt lgkmcnt(10)
    v_mfma_f32_32x32x16_bf16 v[64:79], v[56:59], v[184:187], v[64:79]
    s_add_u32 s46, s45, 4096
    buffer_load_dwordx4 v[180:183], v27, s[12:15], s46 offen offset:2048 sc1
    v_add_u32 v38, 32768, v38
    v_add_u32 v39, 32768, v39
    ds_read_b64_tr_b16 v[56:57], v39 offset:0
    ds_read_b64_tr_b16 v[58:59], v39 offset:512
    s_waitcnt lgkmcnt(10)
    v_mfma_f32_32x32x16_bf16 v[64:79], v[60:63], v[188:191], v[64:79]
    s_add_u32 s46, s44, 4096
    buffer_load_dwordx4 v[184:187], v27, s[12:15], s46 offen offset:3072 sc1
    ds_read_b64_tr_b16 v[60:61], v39 offset:2048
    ds_read_b64_tr_b16 v[62:63], v39 offset:2560
    s_waitcnt lgkmcnt(10)
    v_mfma_f32_32x32x16_bf16 v[64:79], v[40:43], v[192:195], v[64:79]
    s_add_u32 s46, s45, 4096
    buffer_load_dwordx4 v[188:191], v27, s[12:15], s46 offen offset:3072 sc1
    ds_read_b64_tr_b16 v[40:41], v39 offset:4096
    ds_read_b64_tr_b16 v[42:43], v39 offset:4608
    s_waitcnt lgkmcnt(10)
    v_mfma_f32_32x32x16_bf16 v[64:79], v[44:47], v[196:199], v[64:79]
    s_add_u32 s46, s44, 8192
    buffer_load_dwordx4 v[192:195], v27, s[12:15], s46 offen offset:0 sc1
    ds_read_b64_tr_b16 v[44:45], v39 offset:6144
    ds_read_b64_tr_b16 v[46:47], v39 offset:6656
    s_waitcnt lgkmcnt(10)
    v_mfma_f32_32x32x16_bf16 v[64:79], v[48:51], v[200:203], v[64:79]
    s_add_u32 s46, s45, 8192
    buffer_load_dwordx4 v[196:199], v27, s[12:15], s46 offen offset:0 sc1
    v_subrev_u32 v38, 131072, v38
    v_subrev_u32 v39, 131072, v39
    ds_read_b64_tr_b16 v[48:49], v39 offset:0
    ds_read_b64_tr_b16 v[50:51], v39 offset:512
    s_waitcnt lgkmcnt(10)
    v_mfma_f32_32x32x16_bf16 v[64:79], v[52:55], v[204:207], v[64:79]
    s_add_u32 s46, s44, 8192
    buffer_load_dwordx4 v[200:203], v27, s[12:15], s46 offen offset:1024 sc1
    ds_read_b64_tr_b16 v[52:53], v39 offset:2048
    ds_read_b64_tr_b16 v[54:55], v39 offset:2560
    s_waitcnt lgkmcnt(10)
    v_mfma_f32_32x32x16_bf16 v[64:79], v[56:59], v[208:211], v[64:79]
    s_add_u32 s46, s45, 8192
    buffer_load_dwordx4 v[204:207], v27, s[12:15], s46 offen offset:1024 sc1
    ds_read_b64_tr_b16 v[56:57], v39 offset:4096
    ds_read_b64_tr_b16 v[58:59], v39 offset:4608
    s_waitcnt lgkmcnt(10)
    v_mfma_f32_32x32x16_bf16 v[64:79], v[60:63], v[212:215], v[64:79]
    s_add_u32 s46, s44, 8192
    buffer_load_dwordx4 v[208:211], v27, s[12:15], s46 offen offset:2048 sc1
    ds_read_b64_tr_b16 v[60:61], v39 offset:6144
    ds_read_b64_tr_b16 v[62:63], v39 offset:6656
    s_waitcnt lgkmcnt(10)
    v_mfma_f32_32x32x16_bf16 v[64:79], v[40:43], v[216:219], v[64:79]
    s_add_u32 s46, s45, 8192
    buffer_load_dwordx4 v[212:215], v27, s[12:15], s46 offen offset:2048 sc1
    ds_read_b64_tr_b16 v[40:41], v39 offset:16384
    ds_read_b64_tr_b16 v[42:43], v39 offset:16896
    s_waitcnt lgkmcnt(10)
    v_mfma_f32_32x32x16_bf16 v[64:79], v[44:47], v[220:223], v[64:79]
    s_add_u32 s46, s44, 8192
    buffer_load_dwordx4 v[216:219], v27, s[12:15], s46 offen offset:3072 sc1
    ds_read_b64_tr_b16 v[44:45], v39 offset:18432
    ds_read_b64_tr_b16 v[46:47], v39 offset:18944
    s_waitcnt lgkmcnt(10)
    v_mfma_f32_32x32x16_bf16 v[64:79], v[48:51], v[224:227], v[64:79]
    s_add_u32 s46, s45, 8192
    buffer_load_dwordx4 v[220:223], v27, s[12:15], s46 offen offset:3072 sc1
    ds_read_b64_tr_b16 v[48:49], v39 offset:20480
    ds_read_b64_tr_b16 v[50:51], v39 offset:20992
    s_waitcnt lgkmcnt(10)
    v_mfma_f32_32x32x16_bf16 v[64:79], v[52:55], v[228:231], v[64:79]
    s_add_u32 s46, s44, 12288
    buffer_load_dwordx4 v[224:227], v27, s[12:15], s46 offen offset:0 sc1
    ds_read_b64_tr_b16 v[52:53], v39 offset:22528
    ds_read_b64_tr_b16 v[54:55], v39 offset:23040
    s_waitcnt lgkmcnt(10)
    v_mfma_f32_32x32x16_bf16 v[64:79], v[56:59], v[232:235], v[64:79]
    s_add_u32 s46, s45, 12288
    buffer_load_dwordx4 v[228:231], v27, s[12:15], s46 offen offset:0 sc1
    s_waitcnt lgkmcnt(8)
    v_mfma_f32_32x32x16_bf16 v[64:79], v[60:63], v[236:239], v[64:79]
    s_add_u32 s46, s44, 12288
    buffer_load_dwordx4 v[232:235], v27, s[12:15], s46 offen offset:1024 sc1
    s_waitcnt lgkmcnt(6)
    v_mfma_f32_32x32x16_bf16 v[64:79], v[40:43], v[240:243], v[64:79]
    s_add_u32 s46, s45, 12288
    buffer_load_dwordx4 v[236:239], v27, s[12:15], s46 offen offset:1024 sc1
    s_waitcnt lgkmcnt(4)
    v_mfma_f32_32x32x16_bf16 v[64:79], v[44:47], v[244:247], v[64:79]
    s_add_u32 s46, s44, 12288
    buffer_load_dwordx4 v[240:243], v27, s[12:15], s46 offen offset:2048 sc1
    s_waitcnt lgkmcnt(2)
    v_mfma_f32_32x32x16_bf16 v[64:79], v[48:51], v[248:251], v[64:79]
    s_add_u32 s46, s45, 12288
    buffer_load_dwordx4 v[244:247], v27, s[12:15], s46 offen offset:2048 sc1
    s_waitcnt lgkmcnt(0)
    v_mfma_f32_32x32x16_bf16 v[64:79], v[52:55], v[252:255], v[64:79]
    s_add_u32 s46, s44, 12288
    buffer_load_dwordx4 v[248:251], v27, s[12:15], s46 offen offset:3072 sc1
    s_add_u32 s46, s45, 12288
    buffer_load_dwordx4 v[252:255], v27, s[12:15], s46 offen offset:3072 sc1
    v_lshlrev_b32 v13, 3, v0
    v_add_u32 v13, 160832, v13
    ds_read_b64 v[12:13], v13 offset:1536
    s_waitcnt lgkmcnt(0)
    v_mfma_f32_32x32x16_bf16 v[64:79], v[12:15], v[28:31], v[64:79]
    s_nop 7
    s_nop 3
    v_mul_f32 v6, v64, v20
    v_mul_f32 v7, v65, v20
    v_exp_f32 v6, v6
    v_exp_f32 v7, v7
    v_mul_f32 v8, v64, v72
    v_mul_f32 v9, v65, v73
    v_fma_f32 v6, v6, v21, v21
    v_fma_f32 v7, v7, v21, v21
    v_rcp_f32 v6, v6
    v_rcp_f32 v7, v7
    s_nop 0
    v_mul_f32 v8, v8, v6
    v_mul_f32 v9, v9, v7
    v_cvt_pk_bf16_f32 v2, v8, v9
    v_mul_f32 v6, v66, v20
    v_mul_f32 v7, v67, v20
    v_exp_f32 v6, v6
    v_exp_f32 v7, v7
    v_mul_f32 v8, v66, v74
    v_mul_f32 v9, v67, v75
    v_fma_f32 v6, v6, v21, v21
    v_fma_f32 v7, v7, v21, v21
    v_rcp_f32 v6, v6
    v_rcp_f32 v7, v7
    s_nop 0
    v_mul_f32 v8, v8, v6
    v_mul_f32 v9, v9, v7
    v_cvt_pk_bf16_f32 v3, v8, v9
    v_mul_f32 v6, v68, v20
    v_mul_f32 v7, v69, v20
    v_exp_f32 v6, v6
    v_exp_f32 v7, v7
    v_mul_f32 v8, v68, v76
    v_mul_f32 v9, v69, v77
    v_fma_f32 v6, v6, v21, v21
    v_fma_f32 v7, v7, v21, v21
    v_rcp_f32 v6, v6
    v_rcp_f32 v7, v7
    s_nop 0
    v_mul_f32 v8, v8, v6
    v_mul_f32 v9, v9, v7
    v_cvt_pk_bf16_f32 v4, v8, v9
    v_mul_f32 v6, v70, v20
    v_mul_f32 v7, v71, v20
    v_exp_f32 v6, v6
    v_exp_f32 v7, v7
    v_mul_f32 v8, v70, v78
    v_mul_f32 v9, v71, v79
    v_fma_f32 v6, v6, v21, v21
    v_fma_f32 v7, v7, v21, v21
    v_rcp_f32 v6, v6
    v_rcp_f32 v7, v7
    s_lshl_b32 s90, s81, 5
    v_mul_f32 v8, v8, v6
    v_mul_f32 v9, v9, v7
    v_cvt_pk_bf16_f32 v5, v8, v9
    s_add_u32 s90, s90, s68
    s_add_u32 s90, s90, 68608
    buffer_store_dwordx4 v[2:5], v27, s[20:23], s90 offen sc0 sc1
    s_nop 0
    s_branch K1_FIN
K1_FIN:
    s_load_dwordx2 s[36:37], s[0:1], 64
    s_mov_b32 s74, s70
    s_cmp_lg_u32 s5, 0
    s_cbranch_scc1 P2_CH1
    s_and_b32 s94, s2, 7
    s_lshr_b32 s95, s2, 3
    s_and_b32 s94, s94, 1
    s_lshl_b32 s94, s94, 2
    s_and_b32 s95, s95, 3
    s_add_u32 s94, s94, s95
    s_lshl_b32 s94, s94, 5
    v_and_b32 v2, 31, v0
    v_add_u32 v2, s94, v2
    v_lshlrev_b32 v2, 4, v2
    s_mov_b32 s94, 540680
P2_WP0:
    buffer_load_dword v3, v2, s[24:27], s94 offen sc1
    s_waitcnt vmcnt(0)
    v_cmp_ne_u32 vcc, s70, v3
    s_cbranch_vccz P2_WP0_OK
    s_add_u32 s32, s32, 1
    s_cmp_lt_u32 s32, 20000
    s_cbranch_scc1 P2_WP0
P2_WP0_OK:
    s_and_b32 s44, s2, 7
    s_lshr_b32 s45, s2, 3
    s_and_b32 s44, s44, 1
    s_lshl_b32 s44, s44, 2
    s_and_b32 s45, s45, 3
    s_add_u32 s44, s44, s45
    s_add_u32 s12, s66, 11534336
    s_addc_u32 s13, s67, 0
    s_mov_b32 s14, 2883584
    s_mov_b32 s15, 0x00020000
    s_mul_i32 s46, s3, 22528
    s_mul_i32 s44, s44, 360448
    s_add_u32 s44, s44, s46
    s_add_u32 s45, s44, 180224
    s_barrier
    buffer_load_dwordx4 v[128:131], v27, s[12:15], s44 offen offset:0 sc1
    buffer_load_dwordx4 v[132:135], v27, s[12:15], s45 offen offset:0 sc1
    buffer_load_dwordx4 v[136:139], v27, s[12:15], s44 offen offset:1024 sc1
    buffer_load_dwordx4 v[140:143], v27, s[12:15], s45 offen offset:1024 sc1
    buffer_load_dwordx4 v[144:147], v27, s[12:15], s44 offen offset:2048 sc1
    buffer_load_dwordx4 v[148:151], v27, s[12:15], s45 offen offset:2048 sc1
    buffer_load_dwordx4 v[152:155], v27, s[12:15], s44 offen offset:3072 sc1
    buffer_load_dwordx4 v[156:159], v27, s[12:15], s45 offen offset:3072 sc1
    s_add_u32 s46, s44, 4096
    buffer_load_dwordx4 v[160:163], v27, s[12:15], s46 offen offset:0 sc1
    s_add_u32 s46, s45, 4096
    buffer_load_dwordx4 v[164:167], v27, s[12:15], s46 offen offset:0 sc1
    s_add_u32 s46, s44, 4096
    buffer_load_dwordx4 v[168:171], v27, s[12:15], s46 offen offset:1024 sc1
    s_add_u32 s46, s45, 4096
    buffer_load_dwordx4 v[172:175], v27, s[12:15], s46 offen offset:1024 sc1
    s_add_u32 s46, s44, 4096
    buffer_load_dwordx4 v[176:179], v27, s[12:15], s46 offen offset:2048 sc1
    s_add_u32 s46, s45, 4096
    buffer_load_dwordx4 v[180:183], v27, s[12:15], s46 offen offset:2048 sc1
    s_add_u32 s46, s44, 4096
    buffer_load_dwordx4 v[184:187], v27, s[12:15], s46 offen offset:3072 sc1
    s_add_u32 s46, s45, 4096
    buffer_load_dwordx4 v[188:191], v27, s[12:15], s46 offen offset:3072 sc1
    s_add_u32 s46, s44, 8192
    buffer_load_dwordx4 v[192:195], v27, s[12:15], s46 offen offset:0 sc1
    s_add_u32 s46, s45, 8192
    buffer_load_dwordx4 v[196:199], v27, s[12:15], s46 offen offset:0 sc1
    s_add_u32 s46, s44, 8192
    buffer_load_dwordx4 v[200:203], v27, s[12:15], s46 offen offset:1024 sc1
    s_add_u32 s46, s45, 8192
    buffer_load_dwordx4 v[204:207], v27, s[12:15], s46 offen offset:1024 sc1
    s_add_u32 s46, s44, 8192
    buffer_load_dwordx4 v[208:211], v27, s[12:15], s46 offen offset:2048 sc1
    s_add_u32 s46, s45, 8192
    buffer_load_dwordx4 v[212:215], v27, s[12:15], s46 offen offset:2048 sc1
    s_add_u32 s46, s44, 8192
    buffer_load_dwordx4 v[216:219], v27, s[12:15], s46 offen offset:3072 sc1
    s_add_u32 s46, s45, 8192
    buffer_load_dwordx4 v[220:223], v27, s[12:15], s46 offen offset:3072 sc1
    s_add_u32 s46, s44, 12288
    buffer_load_dwordx4 v[224:227], v27, s[12:15], s46 offen offset:0 sc1
    s_add_u32 s46, s45, 12288
    buffer_load_dwordx4 v[228:231], v27, s[12:15], s46 offen offset:0 sc1
    s_add_u32 s46, s44, 12288
    buffer_load_dwordx4 v[232:235], v27, s[12:15], s46 offen offset:1024 sc1
    s_add_u32 s46, s45, 12288
    buffer_load_dwordx4 v[236:239], v27, s[12:15], s46 offen offset:1024 sc1
    s_add_u32 s46, s44, 12288
    buffer_load_dwordx4 v[240:243], v27, s[12:15], s46 offen offset:2048 sc1
    s_add_u32 s46, s45, 12288
    buffer_load_dwordx4 v[244:247], v27, s[12:15], s46 offen offset:2048 sc1
    s_add_u32 s46, s44, 12288
    buffer_load_dwordx4 v[248:251], v27, s[12:15], s46 offen offset:3072 sc1
    s_add_u32 s46, s45, 12288
    buffer_load_dwordx4 v[252:255], v27, s[12:15], s46 offen offset:3072 sc1
    s_branch P2_GOB
P2_CH1:
    s_waitcnt vmcnt(0)
    s_barrier
    s_cmp_lg_u32 s3, 4
    s_cbranch_scc1 P2_GOB
    s_and_b32 s4, s2, 7
    s_lshr_b32 s40, s2, 3
    s_lshr_b32 s38, s4, 1
    s_lshl_b32 s38, s38, 3
    s_lshr_b32 s40, s40, 2
    s_add_u32 s38, s38, s40
    s_lshl_b32 s40, s6, 4
    s_add_u32 s40, s40, s7
    s_lshl_b32 s40, s40, 4
    s_add_u32 s40, s40, 540672
    v_mov_b32 v12, s74
    v_mov_b32 v13, s74
    v_mov_b32 v14, 0
    s_mov_b64 exec, 1
    buffer_store_dwordx2 v[12:13], v14, s[24:27], s40 offen sc0 sc1
    s_mov_b64 exec, -1
    s_lshr_b32 s40, s38, 1
    s_lshl_b32 s40, s40, 4
    v_and_b32 v12, 15, v0
    v_add_u32 v12, s40, v12
    v_lshlrev_b32 v12, 4, v12
    s_mov_b32 s40, 540672
P2_POLL:
    buffer_load_dword v13, v12, s[24:27], s40 offen sc1
    s_waitcnt vmcnt(0)
    v_cmp_ne_u32 vcc, s74, v13
    s_cbranch_vccz P2_GOB
    s_add_u32 s32, s32, 1
    s_cmp_lt_u32 s32, 20000
    s_cbranch_scc1 P2_POLL
P2_GOB:
    s_barrier
P2_JOIN:
    s_waitcnt lgkmcnt(0)
    s_and_b32 s4, s2, 7
    s_lshr_b32 s5, s2, 3
    s_lshr_b32 s38, s4, 1
    s_and_b32 s39, s4, 1
    s_lshl_b32 s38, s38, 3
    s_lshr_b32 s40, s5, 2
    s_add_u32 s38, s38, s40
    s_lshl_b32 s39, s39, 2
    s_and_b32 s40, s5, 3
    s_add_u32 s39, s39, s40
    s_mov_b32 s28, s36
    s_mov_b32 s29, s37
    s_mov_b32 s30, 1024
    s_mov_b32 s31, 0x00020000
    s_mov_b32 s16, s62
    s_mov_b32 s17, s63
    s_mov_b32 s18, 4194304
    s_mov_b32 s19, 0x00020000
    v_lshlrev_b32 v2, 4, v0
    s_mul_i32 s41, s3, 22528
    s_mul_i32 s42, s38, 360448
    s_add_u32 s42, s42, s41
    s_add_u32 s43, s42, 180224
    buffer_load_dwordx4 v[16:19], v2, s[20:23], s42 offen offset:0 sc1
    buffer_load_dwordx4 v[20:23], v2, s[20:23], s43 offen offset:0 sc1
    buffer_load_dwordx4 v[24:27], v2, s[20:23], s42 offen offset:1024 sc1
    buffer_load_dwordx4 v[28:31], v2, s[20:23], s43 offen offset:1024 sc1
    buffer_load_dwordx4 v[32:35], v2, s[20:23], s42 offen offset:2048 sc1
    buffer_load_dwordx4 v[36:39], v2, s[20:23], s43 offen offset:2048 sc1
    buffer_load_dwordx4 v[40:43], v2, s[20:23], s42 offen offset:3072 sc1
    buffer_load_dwordx4 v[44:47], v2, s[20:23], s43 offen offset:3072 sc1
    s_add_u32 s46, s42, 4096
    buffer_load_dwordx4 v[48:51], v2, s[20:23], s46 offen offset:0 sc1
    s_add_u32 s47, s43, 4096
    buffer_load_dwordx4 v[52:55], v2, s[20:23], s47 offen offset:0 sc1
    v_and_b32 v3, 31, v0
    v_lshrrev_b32 v4, 5, v0
    v_bfe_u32 v5, v3, 2, 1
    v_lshlrev_b32 v5, 4, v5
    v_lshrrev_b32 v6, 3, v3
    v_lshl_add_u32 v5, v6, 2, v5
    v_and_b32 v6, 3, v3
    v_add_u32 v5, v5, v6
    s_lshr_b32 s51, s3, 1
    s_and_b32 s46, s51, 1
    s_lshr_b32 s47, s51, 1
    s_lshl_b32 s48, s38, 6
    s_lshl_b32 s46, s46, 5
    s_add_u32 s48, s48, s46
    v_add_u32 v5, s48, v5
    s_lshl_b32 s49, s39, 6
    s_lshl_b32 s47, s47, 5
    s_add_u32 s49, s49, s47
    s_and_b32 s52, s3, 1
    s_lshl_b32 s52, s52, 4
    s_add_u32 s49, s49, s52
    v_lshlrev_b32 v6, 2, v4
    v_add_u32 v6, s49, v6
    v_lshlrev_b32 v7, 3, v5
    v_lshlrev_b32 v8, 10, v5
    v_lshl_add_u32 v8, v6, 1, v8
    v_lshlrev_b32 v9, 1, v6
    v_lshlrev_b32 v10, 11, v5
    v_lshl_add_u32 v10, v6, 2, v10
    buffer_load_dwordx2 v[12:13], v7, s[24:27], 0 offen offset:0 sc1
    buffer_load_dwordx2 v[56:57], v8, s[8:11], 0 offen offset:0
    buffer_load_dwordx2 v[58:59], v8, s[8:11], 0 offen offset:16
    buffer_load_dwordx2 v[60:61], v9, s[28:31], 0 offen offset:0
    buffer_load_dwordx2 v[62:63], v9, s[28:31], 0 offen offset:16
    s_waitcnt vmcnt(13)
    v_mfma_f32_32x32x16_bf16 v[64:79], v[128:131], v[16:19], 0
    v_mfma_f32_32x32x16_bf16 v[80:95], v[128:131], v[20:23], 0
    v_mfma_f32_32x32x16_bf16 v[96:111], v[132:135], v[16:19], 0
    v_mfma_f32_32x32x16_bf16 v[112:127], v[132:135], v[20:23], 0
    s_add_u32 s46, s44, 16384
    buffer_load_dwordx4 v[128:131], v2, s[12:15], s46 offen offset:0 sc1
    s_add_u32 s47, s45, 16384
    buffer_load_dwordx4 v[132:135], v2, s[12:15], s47 offen offset:0 sc1
    s_add_u32 s46, s42, 4096
    buffer_load_dwordx4 v[16:19], v2, s[20:23], s46 offen offset:1024 sc1
    s_add_u32 s47, s43, 4096
    buffer_load_dwordx4 v[20:23], v2, s[20:23], s47 offen offset:1024 sc1
    s_waitcnt vmcnt(15)
    v_mfma_f32_32x32x16_bf16 v[64:79], v[136:139], v[24:27], v[64:79]
    v_mfma_f32_32x32x16_bf16 v[80:95], v[136:139], v[28:31], v[80:95]
    v_mfma_f32_32x32x16_bf16 v[96:111], v[140:143], v[24:27], v[96:111]
    v_mfma_f32_32x32x16_bf16 v[112:127], v[140:143], v[28:31], v[112:127]
    s_add_u32 s46, s44, 16384
    buffer_load_dwordx4 v[136:139], v2, s[12:15], s46 offen offset:1024 sc1
    s_add_u32 s47, s45, 16384
    buffer_load_dwordx4 v[140:143], v2, s[12:15], s47 offen offset:1024 sc1
    s_add_u32 s46, s42, 4096
    buffer_load_dwordx4 v[24:27], v2, s[20:23], s46 offen offset:2048 sc1
    s_add_u32 s47, s43, 4096
    buffer_load_dwordx4 v[28:31], v2, s[20:23], s47 offen offset:2048 sc1
    s_waitcnt vmcnt(17)
    v_mfma_f32_32x32x16_bf16 v[64:79], v[144:147], v[32:35], v[64:79]
    v_mfma_f32_32x32x16_bf16 v[80:95], v[144:147], v[36:39], v[80:95]
    v_mfma_f32_32x32x16_bf16 v[96:111], v[148:151], v[32:35], v[96:111]
    v_mfma_f32_32x32x16_bf16 v[112:127], v[148:151], v[36:39], v[112:127]
    s_add_u32 s46, s44, 16384
    buffer_load_dwordx4 v[144:147], v2, s[12:15], s46 offen offset:2048 sc1
    s_add_u32 s47, s45, 16384
    buffer_load_dwordx4 v[148:151], v2, s[12:15], s47 offen offset:2048 sc1
    s_add_u32 s46, s42, 4096
    buffer_load_dwordx4 v[32:35], v2, s[20:23], s46 offen offset:3072 sc1
    s_add_u32 s47, s43, 4096
    buffer_load_dwordx4 v[36:39], v2, s[20:23], s47 offen offset:3072 sc1
    s_waitcnt vmcnt(19)
    v_mfma_f32_32x32x16_bf16 v[64:79], v[152:155], v[40:43], v[64:79]
    s_waitcnt vmcnt(12)
    v_lshlrev_b32 v14, 16, v12
    v_and_b32 v15, 0xffff0000, v12
    v_rcp_f32 v15, v15
    v_mfma_f32_32x32x16_bf16 v[80:95], v[152:155], v[44:47], v[80:95]
    s_nop 0
    v_lshlrev_b32 v3, 16, v56
    v_and_b32 v4, 0xffff0000, v56
    v_sub_f32 v5, v3, v14
    v_mfma_f32_32x32x16_bf16 v[96:111], v[156:159], v[40:43], v[96:111]
    v_sub_f32 v6, v4, v14
    v_cvt_pk_bf16_f32 v5, v5, v6
    v_lshlrev_b32 v6, 16, v5
    v_and_b32 v5, 0xffff0000, v5
    v_mfma_f32_32x32x16_bf16 v[112:127], v[156:159], v[44:47], v[112:127]
    v_mul_f32 v6, v6, v15
    v_mul_f32 v5, v5, v15
    v_cvt_pk_bf16_f32 v5, v6, v5
    v_lshlrev_b32 v6, 16, v5
    s_add_u32 s46, s44, 16384
    buffer_load_dwordx4 v[152:155], v2, s[12:15], s46 offen offset:3072 sc1
    s_add_u32 s47, s45, 16384
    buffer_load_dwordx4 v[156:159], v2, s[12:15], s47 offen offset:3072 sc1
    s_add_u32 s46, s42, 8192
    buffer_load_dwordx4 v[40:43], v2, s[20:23], s46 offen offset:0 sc1
    s_add_u32 s47, s43, 8192
    buffer_load_dwordx4 v[44:47], v2, s[20:23], s47 offen offset:0 sc1
    v_mfma_f32_32x32x16_bf16 v[64:79], v[160:163], v[48:51], v[64:79]
    v_and_b32 v5, 0xffff0000, v5
    v_lshlrev_b32 v7, 16, v60
    v_and_b32 v8, 0xffff0000, v60
    v_mul_f32 v6, v6, v7
    v_mfma_f32_32x32x16_bf16 v[80:95], v[160:163], v[52:55], v[80:95]
    v_mul_f32 v5, v5, v8
    v_cvt_pk_bf16_f32 v5, v6, v5
    v_lshlrev_b32 v6, 16, v5
    v_and_b32 v5, 0xffff0000, v5
    v_mfma_f32_32x32x16_bf16 v[96:111], v[164:167], v[48:51], v[96:111]
    v_add_f32 v56, v6, v3
    v_add_f32 v60, v5, v4
    v_lshlrev_b32 v3, 16, v57
    v_and_b32 v4, 0xffff0000, v57
    v_mfma_f32_32x32x16_bf16 v[112:127], v[164:167], v[52:55], v[112:127]
    v_sub_f32 v5, v3, v14
    v_sub_f32 v6, v4, v14
    v_cvt_pk_bf16_f32 v5, v5, v6
    v_lshlrev_b32 v6, 16, v5
    s_add_u32 s46, s44, 20480
    buffer_load_dwordx4 v[160:163], v2, s[12:15], s46 offen offset:0 sc1
    s_add_u32 s47, s45, 20480
    buffer_load_dwordx4 v[164:167], v2, s[12:15], s47 offen offset:0 sc1
    s_add_u32 s46, s42, 8192
    buffer_load_dwordx4 v[48:51], v2, s[20:23], s46 offen offset:1024 sc1
    s_add_u32 s47, s43, 8192
    buffer_load_dwordx4 v[52:55], v2, s[20:23], s47 offen offset:1024 sc1
    s_waitcnt vmcnt(16)
    v_mfma_f32_32x32x16_bf16 v[64:79], v[168:171], v[16:19], v[64:79]
    v_and_b32 v5, 0xffff0000, v5
    v_mul_f32 v6, v6, v15
    v_mul_f32 v5, v5, v15
    v_cvt_pk_bf16_f32 v5, v6, v5
    v_mfma_f32_32x32x16_bf16 v[80:95], v[168:171], v[20:23], v[80:95]
    v_lshlrev_b32 v6, 16, v5
    v_and_b32 v5, 0xffff0000, v5
    v_lshlrev_b32 v7, 16, v61
    v_and_b32 v8, 0xffff0000, v61
    v_mfma_f32_32x32x16_bf16 v[96:111], v[172:175], v[16:19], v[96:111]
    v_mul_f32 v6, v6, v7
    v_mul_f32 v5, v5, v8
    v_cvt_pk_bf16_f32 v5, v6, v5
    v_lshlrev_b32 v6, 16, v5
    v_mfma_f32_32x32x16_bf16 v[112:127], v[172:175], v[20:23], v[112:127]
    v_and_b32 v5, 0xffff0000, v5
    v_add_f32 v57, v6, v3
    v_add_f32 v61, v5, v4
    v_lshlrev_b32 v3, 16, v58
    s_add_u32 s46, s44, 20480
    buffer_load_dwordx4 v[168:171], v2, s[12:15], s46 offen offset:1024 sc1
    s_add_u32 s47, s45, 20480
    buffer_load_dwordx4 v[172:175], v2, s[12:15], s47 offen offset:1024 sc1
    s_add_u32 s46, s42, 8192
    buffer_load_dwordx4 v[16:19], v2, s[20:23], s46 offen offset:2048 sc1
    s_add_u32 s47, s43, 8192
    buffer_load_dwordx4 v[20:23], v2, s[20:23], s47 offen offset:2048 sc1
    s_waitcnt vmcnt(16)
    v_mfma_f32_32x32x16_bf16 v[64:79], v[176:179], v[24:27], v[64:79]
    v_and_b32 v4, 0xffff0000, v58
    v_sub_f32 v5, v3, v14
    v_sub_f32 v6, v4, v14
    v_cvt_pk_bf16_f32 v5, v5, v6
    v_mfma_f32_32x32x16_bf16 v[80:95], v[176:179], v[28:31], v[80:95]
    v_lshlrev_b32 v6, 16, v5
    v_and_b32 v5, 0xffff0000, v5
    v_mul_f32 v6, v6, v15
    v_mul_f32 v5, v5, v15
    v_mfma_f32_32x32x16_bf16 v[96:111], v[180:183], v[24:27], v[96:111]
    v_cvt_pk_bf16_f32 v5, v6, v5
    v_lshlrev_b32 v6, 16, v5
    v_and_b32 v5, 0xffff0000, v5
    v_lshlrev_b32 v7, 16, v62
    v_mfma_f32_32x32x16_bf16 v[112:127], v[180:183], v[28:31], v[112:127]
    v_and_b32 v8, 0xffff0000, v62
    v_mul_f32 v6, v6, v7
    v_mul_f32 v5, v5, v8
    v_cvt_pk_bf16_f32 v5, v6, v5
    s_add_u32 s46, s42, 8192
    buffer_load_dwordx4 v[24:27], v2, s[20:23], s46 offen offset:3072 sc1
    s_add_u32 s47, s43, 8192
    buffer_load_dwordx4 v[28:31], v2, s[20:23], s47 offen offset:3072 sc1
    s_waitcnt vmcnt(14)
    v_mfma_f32_32x32x16_bf16 v[64:79], v[184:187], v[32:35], v[64:79]
    v_lshlrev_b32 v6, 16, v5
    v_and_b32 v5, 0xffff0000, v5
    v_add_f32 v58, v6, v3
    v_add_f32 v62, v5, v4
    v_mfma_f32_32x32x16_bf16 v[80:95], v[184:187], v[36:39], v[80:95]
    v_lshlrev_b32 v3, 16, v59
    v_and_b32 v4, 0xffff0000, v59
    v_sub_f32 v5, v3, v14
    v_sub_f32 v6, v4, v14
    v_mfma_f32_32x32x16_bf16 v[96:111], v[188:191], v[32:35], v[96:111]
    v_cvt_pk_bf16_f32 v5, v5, v6
    v_lshlrev_b32 v6, 16, v5
    v_and_b32 v5, 0xffff0000, v5
    v_mul_f32 v6, v6, v15
    v_mfma_f32_32x32x16_bf16 v[112:127], v[188:191], v[36:39], v[112:127]
    v_mul_f32 v5, v5, v15
    v_cvt_pk_bf16_f32 v5, v6, v5
    v_lshlrev_b32 v6, 16, v5
    v_and_b32 v5, 0xffff0000, v5
    s_add_u32 s46, s42, 12288
    buffer_load_dwordx4 v[32:35], v2, s[20:23], s46 offen offset:0 sc1
    s_add_u32 s47, s43, 12288
    buffer_load_dwordx4 v[36:39], v2, s[20:23], s47 offen offset:0 sc1
    s_waitcnt vmcnt(12)
    v_mfma_f32_32x32x16_bf16 v[64:79], v[192:195], v[40:43], v[64:79]
    v_lshlrev_b32 v7, 16, v63
    v_and_b32 v8, 0xffff0000, v63
    v_mul_f32 v6, v6, v7
    v_mul_f32 v5, v5, v8
    v_mfma_f32_32x32x16_bf16 v[80:95], v[192:195], v[44:47], v[80:95]
    v_cvt_pk_bf16_f32 v5, v6, v5
    v_lshlrev_b32 v6, 16, v5
    v_and_b32 v5, 0xffff0000, v5
    v_add_f32 v59, v6, v3
    v_mfma_f32_32x32x16_bf16 v[96:111], v[196:199], v[40:43], v[96:111]
    v_add_f32 v63, v5, v4
    v_mfma_f32_32x32x16_bf16 v[112:127], v[196:199], v[44:47], v[112:127]
    s_add_u32 s46, s42, 12288
    buffer_load_dwordx4 v[40:43], v2, s[20:23], s46 offen offset:1024 sc1
    s_add_u32 s47, s43, 12288
    buffer_load_dwordx4 v[44:47], v2, s[20:23], s47 offen offset:1024 sc1
    s_waitcnt vmcnt(10)
    v_mfma_f32_32x32x16_bf16 v[64:79], v[200:203], v[48:51], v[64:79]
    v_mfma_f32_32x32x16_bf16 v[80:95], v[200:203], v[52:55], v[80:95]
    v_mfma_f32_32x32x16_bf16 v[96:111], v[204:207], v[48:51], v[96:111]
    v_mfma_f32_32x32x16_bf16 v[112:127], v[204:207], v[52:55], v[112:127]
    s_add_u32 s46, s42, 12288
    buffer_load_dwordx4 v[48:51], v2, s[20:23], s46 offen offset:2048 sc1
    s_add_u32 s47, s43, 12288
    buffer_load_dwordx4 v[52:55], v2, s[20:23], s47 offen offset:2048 sc1
    s_waitcnt vmcnt(8)
    v_mfma_f32_32x32x16_bf16 v[64:79], v[208:211], v[16:19], v[64:79]
    v_mfma_f32_32x32x16_bf16 v[80:95], v[208:211], v[20:23], v[80:95]
    v_mfma_f32_32x32x16_bf16 v[96:111], v[212:215], v[16:19], v[96:111]
    v_mfma_f32_32x32x16_bf16 v[112:127], v[212:215], v[20:23], v[112:127]
    s_add_u32 s46, s42, 12288
    buffer_load_dwordx4 v[16:19], v2, s[20:23], s46 offen offset:3072 sc1
    s_add_u32 s47, s43, 12288
    buffer_load_dwordx4 v[20:23], v2, s[20:23], s47 offen offset:3072 sc1
    s_waitcnt vmcnt(8)
    v_mfma_f32_32x32x16_bf16 v[64:79], v[216:219], v[24:27], v[64:79]
    v_mfma_f32_32x32x16_bf16 v[80:95], v[216:219], v[28:31], v[80:95]
    v_mfma_f32_32x32x16_bf16 v[96:111], v[220:223], v[24:27], v[96:111]
    v_mfma_f32_32x32x16_bf16 v[112:127], v[220:223], v[28:31], v[112:127]
    s_add_u32 s46, s42, 16384
    buffer_load_dwordx4 v[24:27], v2, s[20:23], s46 offen offset:0 sc1
    s_add_u32 s47, s43, 16384
    buffer_load_dwordx4 v[28:31], v2, s[20:23], s47 offen offset:0 sc1
    s_waitcnt vmcnt(8)
    v_mfma_f32_32x32x16_bf16 v[64:79], v[224:227], v[32:35], v[64:79]
    v_mfma_f32_32x32x16_bf16 v[80:95], v[224:227], v[36:39], v[80:95]
    v_mfma_f32_32x32x16_bf16 v[96:111], v[228:231], v[32:35], v[96:111]
    v_mfma_f32_32x32x16_bf16 v[112:127], v[228:231], v[36:39], v[112:127]
    s_add_u32 s46, s42, 16384
    buffer_load_dwordx4 v[32:35], v2, s[20:23], s46 offen offset:1024 sc1
    s_add_u32 s47, s43, 16384
    buffer_load_dwordx4 v[36:39], v2, s[20:23], s47 offen offset:1024 sc1
    s_waitcnt vmcnt(8)
    v_mfma_f32_32x32x16_bf16 v[64:79], v[232:235], v[40:43], v[64:79]
    v_mfma_f32_32x32x16_bf16 v[80:95], v[232:235], v[44:47], v[80:95]
    v_mfma_f32_32x32x16_bf16 v[96:111], v[236:239], v[40:43], v[96:111]
    v_mfma_f32_32x32x16_bf16 v[112:127], v[236:239], v[44:47], v[112:127]
    s_add_u32 s46, s42, 16384
    buffer_load_dwordx4 v[40:43], v2, s[20:23], s46 offen offset:2048 sc1
    s_add_u32 s47, s43, 16384
    buffer_load_dwordx4 v[44:47], v2, s[20:23], s47 offen offset:2048 sc1
    s_waitcnt vmcnt(8)
    v_mfma_f32_32x32x16_bf16 v[64:79], v[240:243], v[48:51], v[64:79]
    v_mfma_f32_32x32x16_bf16 v[80:95], v[240:243], v[52:55], v[80:95]
    v_mfma_f32_32x32x16_bf16 v[96:111], v[244:247], v[48:51], v[96:111]
    v_mfma_f32_32x32x16_bf16 v[112:127], v[244:247], v[52:55], v[112:127]
    s_add_u32 s46, s42, 16384
    buffer_load_dwordx4 v[48:51], v2, s[20:23], s46 offen offset:3072 sc1
    s_add_u32 s47, s43, 16384
    buffer_load_dwordx4 v[52:55], v2, s[20:23], s47 offen offset:3072 sc1
    s_waitcnt vmcnt(8)
    v_mfma_f32_32x32x16_bf16 v[64:79], v[248:251], v[16:19], v[64:79]
    v_mfma_f32_32x32x16_bf16 v[80:95], v[248:251], v[20:23], v[80:95]
    v_mfma_f32_32x32x16_bf16 v[96:111], v[252:255], v[16:19], v[96:111]
    v_mfma_f32_32x32x16_bf16 v[112:127], v[252:255], v[20:23], v[112:127]
    s_add_u32 s46, s42, 20480
    buffer_load_dwordx4 v[16:19], v2, s[20:23], s46 offen offset:0 sc1
    s_add_u32 s47, s43, 20480
    buffer_load_dwordx4 v[20:23], v2, s[20:23], s47 offen offset:0 sc1
    s_waitcnt vmcnt(8)
    v_mfma_f32_32x32x16_bf16 v[64:79], v[128:131], v[24:27], v[64:79]
    v_mfma_f32_32x32x16_bf16 v[80:95], v[128:131], v[28:31], v[80:95]
    v_mfma_f32_32x32x16_bf16 v[96:111], v[132:135], v[24:27], v[96:111]
    v_mfma_f32_32x32x16_bf16 v[112:127], v[132:135], v[28:31], v[112:127]
    s_add_u32 s46, s42, 20480
    buffer_load_dwordx4 v[24:27], v2, s[20:23], s46 offen offset:1024 sc1
    s_add_u32 s47, s43, 20480
    buffer_load_dwordx4 v[28:31], v2, s[20:23], s47 offen offset:1024 sc1
    s_waitcnt vmcnt(8)
    v_mfma_f32_32x32x16_bf16 v[64:79], v[136:139], v[32:35], v[64:79]
    v_mfma_f32_32x32x16_bf16 v[80:95], v[136:139], v[36:39], v[80:95]
    v_mfma_f32_32x32x16_bf16 v[96:111], v[140:143], v[32:35], v[96:111]
    v_mfma_f32_32x32x16_bf16 v[112:127], v[140:143], v[36:39], v[112:127]
    s_waitcnt vmcnt(6)
    v_mfma_f32_32x32x16_bf16 v[64:79], v[144:147], v[40:43], v[64:79]
    v_mfma_f32_32x32x16_bf16 v[80:95], v[144:147], v[44:47], v[80:95]
    v_mfma_f32_32x32x16_bf16 v[96:111], v[148:151], v[40:43], v[96:111]
    v_mfma_f32_32x32x16_bf16 v[112:127], v[148:151], v[44:47], v[112:127]
    s_waitcnt vmcnt(4)
    v_mfma_f32_32x32x16_bf16 v[64:79], v[152:155], v[48:51], v[64:79]
    v_mfma_f32_32x32x16_bf16 v[80:95], v[152:155], v[52:55], v[80:95]
    v_mfma_f32_32x32x16_bf16 v[96:111], v[156:159], v[48:51], v[96:111]
    v_mfma_f32_32x32x16_bf16 v[112:127], v[156:159], v[52:55], v[112:127]
    s_waitcnt vmcnt(2)
    v_mfma_f32_32x32x16_bf16 v[64:79], v[160:163], v[16:19], v[64:79]
    v_mfma_f32_32x32x16_bf16 v[80:95], v[160:163], v[20:23], v[80:95]
    v_mfma_f32_32x32x16_bf16 v[96:111], v[164:167], v[16:19], v[96:111]
    v_mfma_f32_32x32x16_bf16 v[112:127], v[164:167], v[20:23], v[112:127]
    s_waitcnt vmcnt(0)
    v_mfma_f32_32x32x16_bf16 v[64:79], v[168:171], v[24:27], v[64:79]
    v_mfma_f32_32x32x16_bf16 v[80:95], v[168:171], v[28:31], v[80:95]
    v_mfma_f32_32x32x16_bf16 v[96:111], v[172:175], v[24:27], v[96:111]
    v_mfma_f32_32x32x16_bf16 v[112:127], v[172:175], v[28:31], v[112:127]
    s_nop 15
    s_mul_i32 s50, s3, 2048
    v_add_u32 v11, s50, v2
    v_add_u32 v9, 65536, v11
    ds_write_b128 v11, v[64:67] offset:0
    ds_write_b128 v11, v[68:71] offset:1024
    ds_write_b128 v11, v[72:75] offset:16384
    ds_write_b128 v11, v[76:79] offset:17408
    ds_write_b128 v11, v[80:83] offset:32768
    ds_write_b128 v11, v[84:87] offset:33792
    ds_write_b128 v11, v[88:91] offset:49152
    ds_write_b128 v11, v[92:95] offset:50176
    ds_write_b128 v9, v[96:99] offset:0
    ds_write_b128 v9, v[100:103] offset:1024
    ds_write_b128 v9, v[104:107] offset:16384
    ds_write_b128 v9, v[108:111] offset:17408
    ds_write_b128 v9, v[112:115] offset:32768
    ds_write_b128 v9, v[116:119] offset:33792
    ds_write_b128 v9, v[120:123] offset:49152
    ds_write_b128 v9, v[124:127] offset:50176
    s_waitcnt lgkmcnt(0)
    s_barrier
    s_mul_i32 s50, s3, 16384
    v_add_u32 v11, s50, v2
    ds_read_b128 v[128:131], v11 offset:0
    ds_read_b128 v[132:135], v11 offset:1024
    ds_read_b128 v[136:139], v11 offset:2048
    ds_read_b128 v[140:143], v11 offset:3072
    ds_read_b128 v[144:147], v11 offset:4096
    ds_read_b128 v[148:151], v11 offset:5120
    ds_read_b128 v[152:155], v11 offset:6144
    ds_read_b128 v[156:159], v11 offset:7168
    ds_read_b128 v[160:163], v11 offset:8192
    ds_read_b128 v[164:167], v11 offset:9216
    ds_read_b128 v[168:171], v11 offset:10240
    ds_read_b128 v[172:175], v11 offset:11264
    ds_read_b128 v[176:179], v11 offset:12288
    ds_read_b128 v[180:183], v11 offset:13312
    ds_read_b128 v[184:187], v11 offset:14336
    ds_read_b128 v[188:191], v11 offset:15360
    s_waitcnt lgkmcnt(0)
    v_add_f32 v128, v128, v160
    v_add_f32 v129, v129, v161
    v_add_f32 v130, v130, v162
    v_add_f32 v131, v131, v163
    v_add_f32 v132, v132, v164
    v_add_f32 v133, v133, v165
    v_add_f32 v134, v134, v166
    v_add_f32 v135, v135, v167
    v_add_f32 v136, v136, v168
    v_add_f32 v137, v137, v169
    v_add_f32 v138, v138, v170
    v_add_f32 v139, v139, v171
    v_add_f32 v140, v140, v172
    v_add_f32 v141, v141, v173
    v_add_f32 v142, v142, v174
    v_add_f32 v143, v143, v175
    v_add_f32 v144, v144, v176
    v_add_f32 v145, v145, v177
    v_add_f32 v146, v146, v178
    v_add_f32 v147, v147, v179
    v_add_f32 v148, v148, v180
    v_add_f32 v149, v149, v181
    v_add_f32 v150, v150, v182
    v_add_f32 v151, v151, v183
    v_add_f32 v152, v152, v184
    v_add_f32 v153, v153, v185
    v_add_f32 v154, v154, v186
    v_add_f32 v155, v155, v187
    v_add_f32 v156, v156, v188
    v_add_f32 v157, v157, v189
    v_add_f32 v158, v158, v190
    v_add_f32 v159, v159, v191
    v_add_f32 v128, v128, v144
    v_add_f32 v129, v129, v145
    v_add_f32 v130, v130, v146
    v_add_f32 v131, v131, v147
    v_add_f32 v132, v132, v148
    v_add_f32 v133, v133, v149
    v_add_f32 v134, v134, v150
    v_add_f32 v135, v135, v151
    v_add_f32 v136, v136, v152
    v_add_f32 v137, v137, v153
    v_add_f32 v138, v138, v154
    v_add_f32 v139, v139, v155
    v_add_f32 v140, v140, v156
    v_add_f32 v141, v141, v157
    v_add_f32 v142, v142, v158
    v_add_f32 v143, v143, v159
    v_add_f32 v128, v128, v136
    v_add_f32 v129, v129, v137
    v_add_f32 v130, v130, v138
    v_add_f32 v131, v131, v139
    v_add_f32 v132, v132, v140
    v_add_f32 v133, v133, v141
    v_add_f32 v134, v134, v142
    v_add_f32 v135, v135, v143
    v_add_f32 v128, v128, v56
    v_add_f32 v129, v129, v60
    v_add_f32 v130, v130, v57
    v_add_f32 v131, v131, v61
    v_add_f32 v132, v132, v58
    v_add_f32 v133, v133, v62
    v_add_f32 v134, v134, v59
    v_add_f32 v135, v135, v63
    buffer_store_dwordx4 v[128:131], v10, s[16:19], 0 offen offset:0
    buffer_store_dwordx4 v[132:135], v10, s[16:19], 0 offen offset:32
K1_END:
    s_endpgm
K1C0_ST_SLOW:
    s_sleep 1
    v_lshlrev_b32 v10, 3, v16
    buffer_load_dwordx2 v[10:11], v10, s[24:27], s71 offen offset:0 sc1
    s_waitcnt vmcnt(0)
    v_cmp_ne_u32 vcc, s70, v11
    s_cbranch_vccz K1C0_ST_OK
    s_add_u32 s32, s32, 1
    s_cmp_lt_u32 s32, 20000
    s_cbranch_scc1 K1C0_ST_SLOW
    s_branch K1C0_ST_OK
K1C0_CS0_SLOW:
    s_sleep 1
    s_add_u32 s90, s69, 0
    buffer_load_dwordx4 v[108:111], v27, s[24:27], s90 offen sc1
    s_waitcnt vmcnt(0)
    v_cmp_ne_u32 vcc, s70, v109
    v_cmp_ne_u32 s[90:91], s70, v111
    s_or_b64 vcc, vcc, s[90:91]
    s_cbranch_vccz K1C0_CS0_OK
    s_add_u32 s32, s32, 1
    s_cmp_lt_u32 s32, 20000
    s_cbranch_scc1 K1C0_CS0_SLOW
    s_branch K1C0_CS0_OK
K1C0_CS1_SLOW:
    s_sleep 1
    s_add_u32 s90, s69, 1024
    buffer_load_dwordx4 v[112:115], v27, s[24:27], s90 offen sc1
    s_waitcnt vmcnt(0)
    v_cmp_ne_u32 vcc, s70, v113
    v_cmp_ne_u32 s[90:91], s70, v115
    s_or_b64 vcc, vcc, s[90:91]
    s_cbranch_vccz K1C0_CS1_OK
    s_add_u32 s32, s32, 1
    s_cmp_lt_u32 s32, 20000
    s_cbranch_scc1 K1C0_CS1_SLOW
    s_branch K1C0_CS1_OK
K1C0_CS4_SLOW:
    s_sleep 1
    s_add_u32 s90, s69, 4096
    buffer_load_dwordx4 v[116:119], v27, s[24:27], s90 offen sc1
    s_waitcnt vmcnt(0)
    v_cmp_ne_u32 vcc, s70, v117
    v_cmp_ne_u32 s[90:91], s70, v119
    s_or_b64 vcc, vcc, s[90:91]
    s_cbranch_vccz K1C0_CS4_OK
    s_add_u32 s32, s32, 1
    s_cmp_lt_u32 s32, 20000
    s_cbranch_scc1 K1C0_CS4_SLOW
    s_branch K1C0_CS4_OK
K1C0_CS5_SLOW:
    s_sleep 1
    s_add_u32 s90, s69, 5120
    buffer_load_dwordx4 v[120:123], v27, s[24:27], s90 offen sc1
    s_waitcnt vmcnt(0)
    v_cmp_ne_u32 vcc, s70, v121
    v_cmp_ne_u32 s[90:91], s70, v123
    s_or_b64 vcc, vcc, s[90:91]
    s_cbranch_vccz K1C0_CS5_OK
    s_add_u32 s32, s32, 1
    s_cmp_lt_u32 s32, 20000
    s_cbranch_scc1 K1C0_CS5_SLOW
    s_branch K1C0_CS5_OK
K1C0_E_SLOW:
    s_sleep 1
    s_lshl_b32 s90, s7, 13
    s_add_u32 s90, s90, 409600
    s_add_u32 s91, s90, 4096
    v_and_b32 v2, 31, v0
    v_lshlrev_b32 v2, 4, v2
    buffer_load_dwordx4 v[160:163], v2, s[24:27], s90 offen offset:0 sc1
    buffer_load_dwordx4 v[164:167], v2, s[24:27], s90 offen offset:512 sc1
    buffer_load_dwordx4 v[168:171], v2, s[24:27], s90 offen offset:1024 sc1
    buffer_load_dwordx4 v[172:175], v2, s[24:27], s90 offen offset:1536 sc1
    buffer_load_dwordx4 v[176:179], v2, s[24:27], s90 offen offset:2048 sc1
    buffer_load_dwordx4 v[180:183], v2, s[24:27], s90 offen offset:2560 sc1
    buffer_load_dwordx4 v[184:187], v2, s[24:27], s90 offen offset:3072 sc1
    buffer_load_dwordx4 v[188:191], v2, s[24:27], s90 offen offset:3584 sc1
    buffer_load_dwordx4 v[192:195], v2, s[24:27], s91 offen offset:0 sc1
    buffer_load_dwordx4 v[196:199], v2, s[24:27], s91 offen offset:512 sc1
    buffer_load_dwordx4 v[200:203], v2, s[24:27], s91 offen offset:1024 sc1
    buffer_load_dwordx4 v[204:207], v2, s[24:27], s91 offen offset:1536 sc1
    buffer_load_dwordx4 v[208:211], v2, s[24:27], s91 offen offset:2048 sc1
    buffer_load_dwordx4 v[212:215], v2, s[24:27], s91 offen offset:2560 sc1
    buffer_load_dwordx4 v[216:219], v2, s[24:27], s91 offen offset:3072 sc1
    buffer_load_dwordx4 v[220:223], v2, s[24:27], s91 offen offset:3584 sc1
    s_waitcnt vmcnt(0)
    v_mov_b32 v3, 0
    s_cmp_le_u32 s6, 0
    s_cbranch_scc1 K1C0_TCDS
    v_xor_b32 v4, s70, v161
    v_xor_b32 v5, s70, v163
    v_or3_b32 v3, v3, v4, v5
    s_cmp_le_u32 s6, 1
    s_cbranch_scc1 K1C0_TCDS
    v_xor_b32 v4, s70, v165
    v_xor_b32 v5, s70, v167
    v_or3_b32 v3, v3, v4, v5
    s_cmp_le_u32 s6, 2
    s_cbranch_scc1 K1C0_TCDS
    v_xor_b32 v4, s70, v169
    v_xor_b32 v5, s70, v171
    v_or3_b32 v3, v3, v4, v5
    s_cmp_le_u32 s6, 3
    s_cbranch_scc1 K1C0_TCDS
    v_xor_b32 v4, s70, v173
    v_xor_b32 v5, s70, v175
    v_or3_b32 v3, v3, v4, v5
    s_cmp_le_u32 s6, 4
    s_cbranch_scc1 K1C0_TCDS
    v_xor_b32 v4, s70, v177
    v_xor_b32 v5, s70, v179
    v_or3_b32 v3, v3, v4, v5
    s_cmp_le_u32 s6, 5
    s_cbranch_scc1 K1C0_TCDS
    v_xor_b32 v4, s70, v181
    v_xor_b32 v5, s70, v183
    v_or3_b32 v3, v3, v4, v5
    s_cmp_le_u32 s6, 6
    s_cbranch_scc1 K1C0_TCDS
    v_xor_b32 v4, s70, v185
    v_xor_b32 v5, s70, v187
    v_or3_b32 v3, v3, v4, v5
    s_cmp_le_u32 s6, 7
    s_cbranch_scc1 K1C0_TCDS
    v_xor_b32 v4, s70, v189
    v_xor_b32 v5, s70, v191
    v_or3_b32 v3, v3, v4, v5
    s_cmp_le_u32 s6, 8
    s_cbranch_scc1 K1C0_TCDS
    v_xor_b32 v4, s70, v193
    v_xor_b32 v5, s70, v195
    v_or3_b32 v3, v3, v4, v5
    s_cmp_le_u32 s6, 9
    s_cbranch_scc1 K1C0_TCDS
    v_xor_b32 v4, s70, v197
    v_xor_b32 v5, s70, v199
    v_or3_b32 v3, v3, v4, v5
    s_cmp_le_u32 s6, 10
    s_cbranch_scc1 K1C0_TCDS
    v_xor_b32 v4, s70, v201
    v_xor_b32 v5, s70, v203
    v_or3_b32 v3, v3, v4, v5
    s_cmp_le_u32 s6, 11
    s_cbranch_scc1 K1C0_TCDS
    v_xor_b32 v4, s70, v205
    v_xor_b32 v5, s70, v207
    v_or3_b32 v3, v3, v4, v5
    s_cmp_le_u32 s6, 12
    s_cbranch_scc1 K1C0_TCDS
    v_xor_b32 v4, s70, v209
    v_xor_b32 v5, s70, v211
    v_or3_b32 v3, v3, v4, v5
    s_cmp_le_u32 s6, 13
    s_cbranch_scc1 K1C0_TCDS
    v_xor_b32 v4, s70, v213
    v_xor_b32 v5, s70, v215
    v_or3_b32 v3, v3, v4, v5
    s_cmp_le_u32 s6, 14
    s_cbranch_scc1 K1C0_TCDS
    v_xor_b32 v4, s70, v217
    v_xor_b32 v5, s70, v219
    v_or3_b32 v3, v3, v4, v5
K1C0_TCDS:
    v_cmp_ne_u32 vcc, 0, v3
    s_cbranch_vccz K1C0_E_OK
    s_add_u32 s32, s32, 1
    s_cmp_lt_u32 s32, 20000
    s_cbranch_scc1 K1C0_E_SLOW
    s_branch K1C0_E_OK
K1C1_ST_SLOW:
    s_sleep 1
    v_lshlrev_b32 v10, 3, v16
    buffer_load_dwordx2 v[10:11], v10, s[24:27], s71 offen offset:0 sc1
    s_waitcnt vmcnt(0)
    v_cmp_ne_u32 vcc, s70, v11
    s_cbranch_vccz K1C1_ST_OK
    s_add_u32 s32, s32, 1
    s_cmp_lt_u32 s32, 20000
    s_cbranch_scc1 K1C1_ST_SLOW
    s_branch K1C1_ST_OK
K1C1_CS2_SLOW:
    s_sleep 1
    s_add_u32 s90, s69, 2048
    buffer_load_dwordx4 v[108:111], v27, s[24:27], s90 offen sc1
    s_waitcnt vmcnt(0)
    v_cmp_ne_u32 vcc, s70, v109
    v_cmp_ne_u32 s[90:91], s70, v111
    s_or_b64 vcc, vcc, s[90:91]
    s_cbranch_vccz K1C1_CS2_OK
    s_add_u32 s32, s32, 1
    s_cmp_lt_u32 s32, 20000
    s_cbranch_scc1 K1C1_CS2_SLOW
    s_branch K1C1_CS2_OK
K1C1_CS3_SLOW:
    s_sleep 1
    s_add_u32 s90, s69, 3072
    buffer_load_dwordx4 v[112:115], v27, s[24:27], s90 offen sc1
    s_waitcnt vmcnt(0)
    v_cmp_ne_u32 vcc, s70, v113
    v_cmp_ne_u32 s[90:91], s70, v115
    s_or_b64 vcc, vcc, s[90:91]
    s_cbranch_vccz K1C1_CS3_OK
    s_add_u32 s32, s32, 1
    s_cmp_lt_u32 s32, 20000
    s_cbranch_scc1 K1C1_CS3_SLOW
    s_branch K1C1_CS3_OK
K1C1_CS6_SLOW:
    s_sleep 1
    s_add_u32 s90, s69, 6144
    buffer_load_dwordx4 v[116:119], v27, s[24:27], s90 offen sc1
    s_waitcnt vmcnt(0)
    v_cmp_ne_u32 vcc, s70, v117
    v_cmp_ne_u32 s[90:91], s70, v119
    s_or_b64 vcc, vcc, s[90:91]
    s_cbranch_vccz K1C1_CS6_OK
    s_add_u32 s32, s32, 1
    s_cmp_lt_u32 s32, 20000
    s_cbranch_scc1 K1C1_CS6_SLOW
    s_branch K1C1_CS6_OK
K1C1_CS7_SLOW:
    s_sleep 1
    s_add_u32 s90, s69, 7168
    buffer_load_dwordx4 v[120:123], v27, s[24:27], s90 offen sc1
    s_waitcnt vmcnt(0)
    v_cmp_ne_u32 vcc, s70, v121
    v_cmp_ne_u32 s[90:91], s70, v123
    s_or_b64 vcc, vcc, s[90:91]
    s_cbranch_vccz K1C1_CS7_OK
    s_add_u32 s32, s32, 1
    s_cmp_lt_u32 s32, 20000
    s_cbranch_scc1 K1C1_CS7_SLOW
    s_branch K1C1_CS7_OK
K1C1_CS8_SLOW:
    s_sleep 1
    s_add_u32 s90, s69, 8192
    buffer_load_dwordx4 v[124:127], v27, s[24:27], s90 offen sc1
    s_waitcnt vmcnt(0)
    v_cmp_ne_u32 vcc, s70, v125
    v_cmp_ne_u32 s[90:91], s70, v127
    s_or_b64 vcc, vcc, s[90:91]
    s_cbranch_vccz K1C1_CS8_OK
    s_add_u32 s32, s32, 1
    s_cmp_lt_u32 s32, 20000
    s_cbranch_scc1 K1C1_CS8_SLOW
    s_branch K1C1_CS8_OK
K1_CODE_END:
    s_endpgm
.section .rodata,"a"
.p2align 6
.amdhsa_kernel parallel_sum__ssm_conv_s5__glu_gated_swiglu__prompt_kernel
  .amdhsa_next_free_vgpr 256
  .amdhsa_next_free_sgpr 102
  .amdhsa_accum_offset 256
  .amdhsa_group_segment_fixed_size 0
  .amdhsa_kernarg_size 128
  .amdhsa_user_sgpr_count 2
  .amdhsa_user_sgpr_kernarg_segment_ptr 1
  .amdhsa_system_sgpr_workgroup_id_x 1
.end_amdhsa_kernel
```
